```python
import torch

def _softmax(x, axis=-1):
    return torch.softmax(x, dim=axis)

def _gelu(x):
    return torch.nn.functional.gelu(x, approximate='tanh')

def _silu(x):
    return torch.nn.functional.silu(x)

def _sigmoid(x):
    return torch.sigmoid(x)

def _layernorm(x, axis=-1, eps=1e-05):
    m = x.mean(dim=axis, keepdim=True)
    v = x.var(dim=axis, keepdim=True, unbiased=False)
    return (x - m) / torch.sqrt(v + eps)

def _scatter_add(tgt, idx, src, axis=0):
    return tgt.clone().index_add_(axis, idx, src)

def _segment_sum(src, seg, n):
    out = torch.zeros((n,) + src.shape[1:], dtype=src.dtype)
    return out.index_add_(0, seg, src)

def _pad(x, pw):
    flat = tuple((v for pair in reversed(pw) for v in pair))
    return torch.nn.functional.pad(x, flat)
kernel_name = 'standalone__tensor_product_equiv_tfn__graph'

def setup_inputs():

    _w = lambda a: (lambda t: t.to(torch.bfloat16) if t.is_floating_point() else t)(torch.as_tensor(a))
    N, deg, C, L, DE = (10000, 64, 64, 1, 16)
    E = N * deg
    M = (L + 1) ** 2
    src = (lambda lo, hi, *s: torch.randint(lo, hi, s))(0, N, E).to(torch.int64)
    dst = (lambda lo, hi, *s: torch.randint(lo, hi, s))(0, N, E).to(torch.int64)
    r = (lambda *s: torch.randn(*s, dtype=torch.bfloat16) * 0.05)(E, 3)
    r = r / (torch.linalg.norm(r, dim=-1, keepdim=True) + 1e-09)
    rx, ry, rz = (r[:, 0].clone(), r[:, 1].clone(), r[:, 2].clone())
    Ys = [torch.ones((E, 1), dtype=float)]
    if L >= 1:
        Ys.append(r.to(float))
    if L >= 2:
        Ys.append(torch.stack([2 * rx * ry, 2 * ry * rz, (3 * rz * rz - 1.0) / (lambda _x: torch.sqrt(torch.as_tensor(_x)))(3.0), 2 * rx * rz, rx * rx - ry * ry], dim=-1).to(float))
    for _l in range(3, L + 1):
        Ys.append(((lambda *s: torch.randn(*s, dtype=torch.bfloat16) * 0.05)(E, 2 * _l + 1) * 0.3).to(float))
    Y = torch.cat(Ys, dim=-1)
    cg = torch.zeros((M, M, M), dtype=float)
    off = [_l * _l for _l in range(L + 2)]
    for l1 in range(L + 1):
        for l2 in range(L + 1):
            for l3 in range(abs(l1 - l2), min(L, l1 + l2) + 1):
                d1, d2, d3 = (2 * l1 + 1, 2 * l2 + 1, 2 * l3 + 1)
                cg[off[l1]:off[l1 + 1], off[l2]:off[l2 + 1], off[l3]:off[l3 + 1]] = (lambda *s: torch.randn(*s, dtype=torch.bfloat16) * 0.05)(d1, d2, d3) / (lambda _x: torch.sqrt(torch.as_tensor(_x)))(float(d1 * d2))
    return {'x': _w((lambda *s: torch.randn(*s, dtype=torch.bfloat16) * 0.05)(N, C, M) * 0.2), 'src': _w(src), 'dst': _w(dst), 'Y': _w(Y), 'edge_feat': _w((lambda *s: torch.randn(*s, dtype=torch.bfloat16) * 0.05)(E, DE)), 'w_rad': _w((lambda *s: torch.randn(*s, dtype=torch.bfloat16) * 0.05)(DE, C) * (1.0 / max(1.0, DE) ** 0.5)), 'cg': _w(cg), 'w_mix': _w((lambda *s: torch.randn(*s, dtype=torch.bfloat16) * 0.05)(C, C) * (1.0 / max(1.0, C) ** 0.5))}

def reference(x, src, dst, Y, edge_feat, w_rad, cg, w_mix):
    N, C, M = (x.shape[0], x.shape[1], x.shape[2])
    R = _silu(edge_feat @ w_rad)
    xs = x[src]
    tp = torch.einsum('eci,ef,ifo->eco', xs, Y, cg)
    msg = R[:, :, None] * tp
    agg = _segment_sum(msg.reshape(-1, C * M), dst, N).reshape(N, C, M)
    return torch.einsum('ncm,cd->ndm', agg, w_mix)
```

```asm
; @launch grid=(256,1,1) block=(1024,1,1) lds=161984
.amdgcn_target "amdgcn-amd-amdhsa--gfx950"
.text
.globl standalone__tensor_product_equiv_tfn__graph_kernel
.p2align 8
.type standalone__tensor_product_equiv_tfn__graph_kernel,@function
standalone__tensor_product_equiv_tfn__graph_kernel:
    s_cmp_ge_u32 s2, 256
    s_cbranch_scc1 L_end
    s_load_dwordx16 s[56:71], s[0:1], 0
    s_load_dwordx4 s[72:75], s[0:1], 64
    s_load_dwordx2 s[10:11], s[0:1], 80
    v_lshrrev_b32 v2, 6, v0
    v_lshlrev_b32 v46, 4, v0
    v_readfirstlane_b32 s39, v2
    v_mov_b32 v22, 134144
    v_mov_b32 v4, 0
    v_and_b32 v3, 0xff, v0
    v_lshl_add_u32 v3, v3, 2, v22
    ds_write_b32 v3, v4
    s_cmp_lt_u32 s39, 10
    s_cbranch_scc1 L_a_first
    s_getpc_b64 s[8:9]
L_pc:
    s_lshl_b32 s3, s39, 5
    s_lshr_b32 s7, s2, 3
    s_add_u32 s3, s3, s7
    s_sub_u32 s3, s3, 320
    s_lshl_b32 s3, s3, 7
    s_min_u32 s3, s3, L_end-L_pc
    s_add_u32 s8, s8, s3
    s_addc_u32 s9, s9, 0
    v_mov_b32 v10, s8
    v_mov_b32 v11, s9
    global_load_dword v115, v[10:11], off
    s_xor_b32 s3, s39, 10
    s_or_b32 s3, s3, s2
    s_cbranch_scc1 L_notag
    s_memrealtime s[8:9]
L_notag:
    s_waitcnt lgkmcnt(0)
    s_mov_b32 s28, s74
    s_mov_b32 s29, s75
    s_mov_b32 s30, 256
    s_mov_b32 s31, 0x20000
    s_cbranch_scc1 L_nopub
    s_and_b32 s9, s9, 0xff
    s_or_b32 s9, s9, 0x100
    v_mov_b32 v12, s8
    v_mov_b32 v13, s9
    v_and_b32 v9, 15, v0
    v_lshlrev_b32 v9, 3, v9
    s_mov_b64 exec, 65535
    buffer_store_dwordx2 v[12:13], v9, s[28:31], 0 offen sc1
    s_mov_b64 exec, -1
L_nopub:
    s_barrier
    s_branch L_helper
L_a_first:
    v_cmp_gt_u32 vcc, 625, v0
    s_mov_b64 exec, vcc
    v_lshlrev_b32 v2, 5, v0
    v_lshlrev_b32 v3, 2, v0
    s_mul_i32 s3, s2, 10000
    s_mul_i32 s7, s2, 20000
    s_waitcnt lgkmcnt(0)
    s_mov_b32 s28, s60
    s_mov_b32 s29, s61
    s_mov_b32 s30, 2560000
    s_mov_b32 s31, 0x20000
    buffer_load_dwordx4 v[4:7], v46, s[28:31], s3 offen
    s_mov_b32 s40, s58
    s_mov_b32 s41, s59
    s_mov_b32 s42, 2560000
    s_mov_b32 s43, 0x20000
    s_mov_b32 s44, s62
    s_mov_b32 s45, s63
    s_mov_b32 s46, 5120000
    s_mov_b32 s47, 0x20000
    s_barrier
    buffer_load_dwordx4 v[8:11], v46, s[40:43], s3 offen
    buffer_load_dwordx4 v[12:15], v2, s[44:47], s7 offen
    buffer_load_dwordx4 v[16:19], v2, s[44:47], s7 offen offset:16
    s_mov_b32 s12, s56
    s_mov_b32 s13, s57
    s_mov_b32 s14, 5120000
    s_mov_b32 s15, 0x20000
    s_mov_b32 s16, s64
    s_mov_b32 s17, s65
    s_mov_b32 s18, 20480000
    s_mov_b32 s19, 0x20000
    s_mov_b32 s32, s72
    s_mov_b32 s33, s73
    s_mov_b32 s34, 5120000
    s_mov_b32 s35, 0x20000
    s_add_u32 s20, s10, 0x1000000
    s_addc_u32 s21, s11, 0
    s_mov_b32 s22, 7700480
    s_mov_b32 s23, 0x20000
    s_add_u32 s24, s10, 0x800000
    s_addc_u32 s25, s11, 0
    s_mov_b32 s26, 524288
    s_mov_b32 s27, 0x20000
    s_mov_b32 s8, 214749
    s_movk_i32 s9, 625
    v_mov_b32 v21, 1
    s_waitcnt vmcnt(3)
    v_mul_u32_u24 v24, s8, v4
    v_lshrrev_b32 v24, 23, v24
    v_lshl_add_u32 v28, v24, 2, v22
    ds_add_rtn_u32 v32, v28, v21
    v_mul_u32_u24 v25, s8, v5
    v_lshrrev_b32 v25, 23, v25
    v_lshl_add_u32 v29, v25, 2, v22
    ds_add_rtn_u32 v33, v29, v21
    v_mul_u32_u24 v26, s8, v6
    v_lshrrev_b32 v26, 23, v26
    v_lshl_add_u32 v30, v26, 2, v22
    ds_add_rtn_u32 v34, v30, v21
    v_mul_u32_u24 v27, s8, v7
    v_lshrrev_b32 v27, 23, v27
    v_lshl_add_u32 v31, v27, 2, v22
    ds_add_rtn_u32 v35, v31, v21
    v_mad_u32_u24 v24, v24, s9, 15
    v_lshrrev_b32 v24, 4, v24
    v_sub_u32 v24, v4, v24
    v_add_u32 v36, 0, v3
    v_lshlrev_b32 v36, 20, v36
    v_lshl_or_b32 v36, v24, 14, v36
    v_mad_u32_u24 v25, v25, s9, 15
    v_lshrrev_b32 v25, 4, v25
    v_sub_u32 v25, v5, v25
    v_add_u32 v37, 1, v3
    v_lshlrev_b32 v37, 20, v37
    v_lshl_or_b32 v37, v25, 14, v37
    v_mad_u32_u24 v26, v26, s9, 15
    v_lshrrev_b32 v26, 4, v26
    v_sub_u32 v26, v6, v26
    v_add_u32 v38, 2, v3
    v_lshlrev_b32 v38, 20, v38
    v_lshl_or_b32 v38, v26, 14, v38
    v_mad_u32_u24 v27, v27, s9, 15
    v_lshrrev_b32 v27, 4, v27
    v_sub_u32 v27, v7, v27
    v_add_u32 v39, 3, v3
    v_lshlrev_b32 v39, 20, v39
    v_lshl_or_b32 v39, v27, 14, v39
    s_waitcnt lgkmcnt(0)
    s_barrier
    s_cmp_lg_u32 s39, 0
    s_cbranch_scc1 L_a_noscan
    v_add_u32 v47, v46, v22
    ds_read_b128 v[40:43], v47
    s_waitcnt lgkmcnt(0)
    v_add_u32 v49, v40, v41
    v_add_u32 v50, v49, v42
    v_add_u32 v51, v50, v43
    v_mov_b32 v52, v51
    s_nop 0
    v_add_u32_dpp v51, v51, v51 row_shr:1
    s_nop 1
    v_add_u32_dpp v51, v51, v51 row_shr:2
    s_nop 1
    v_add_u32_dpp v51, v51, v51 row_shr:4
    s_nop 1
    v_add_u32_dpp v51, v51, v51 row_shr:8
    s_nop 1
    v_add_u32_dpp v51, v51, v51 row_bcast:15 row_mask:0xa
    s_nop 1
    v_add_u32_dpp v51, v51, v51 row_bcast:31 row_mask:0xc
    v_sub_u32 v48, v51, v52
    v_add_u32 v51, v48, v50
    v_add_u32 v50, v48, v49
    v_add_u32 v49, v48, v40
    ds_write_b128 v47, v[48:51]
    s_waitcnt lgkmcnt(0)
L_a_noscan:
    s_barrier
    ds_read_b32 v24, v28
    ds_read_b32 v25, v29
    ds_read_b32 v26, v30
    ds_read_b32 v27, v31
    v_and_b32 v47, 0x7f, v0
    v_lshl_add_u32 v47, v47, 3, v22
    ds_read_b64 v[40:41], v47
    ds_read_b32 v42, v47 offset:8
    s_waitcnt vmcnt(2)
    v_or_b32 v36, v36, v8
    s_waitcnt lgkmcnt(5)
    v_add_u32 v24, v24, v32
    v_mul_u32_u24 v24, 12, v24
    v_or_b32 v37, v37, v9
    s_waitcnt lgkmcnt(4)
    v_add_u32 v25, v25, v33
    v_mul_u32_u24 v25, 12, v25
    v_or_b32 v38, v38, v10
    s_waitcnt lgkmcnt(3)
    v_add_u32 v26, v26, v34
    v_mul_u32_u24 v26, 12, v26
    v_or_b32 v39, v39, v11
    s_waitcnt lgkmcnt(2)
    v_add_u32 v27, v27, v35
    v_mul_u32_u24 v27, 12, v27
    ds_write_b32 v24, v36 offset:8
    ds_write_b32 v25, v37 offset:8
    ds_write_b32 v26, v38 offset:8
    ds_write_b32 v27, v39 offset:8
    s_waitcnt lgkmcnt(4)
    v_sub_u32 v42, v42, v41
    v_sub_u32 v43, v41, v40
    v_lshl_or_b32 v42, v42, 12, v41
    v_lshl_or_b32 v40, v43, 12, v40
    s_mul_i32 s3, s2, 30080
    s_waitcnt vmcnt(0)
    ds_write2_b32 v24, v12, v13 offset0:0 offset1:1
    ds_write2_b32 v25, v14, v15 offset0:0 offset1:1
    ds_write2_b32 v26, v16, v17 offset0:0 offset1:1
    ds_write2_b32 v27, v18, v19 offset0:0 offset1:1
    s_mov_b64 exec, -1
    v_cmp_gt_u32 vcc, 600, v0
    s_waitcnt lgkmcnt(0)
    s_barrier
    ds_read_b128 v[48:51], v46 offset:0
    ds_read_b128 v[52:55], v46 offset:10240
    ds_read_b128 v[56:59], v46 offset:20480
    s_waitcnt lgkmcnt(2)
    buffer_store_dwordx4 v[48:51], v46, s[20:23], s3 offen sc1
    s_add_u32 s3, s3, 10240
    s_waitcnt lgkmcnt(1)
    buffer_store_dwordx4 v[52:55], v46, s[20:23], s3 offen sc1
    s_add_u32 s3, s3, 10240
    s_waitcnt lgkmcnt(0)
    s_mov_b64 exec, vcc
    buffer_store_dwordx4 v[56:59], v46, s[20:23], s3 offen sc1
    s_mov_b64 exec, -1
    s_branch L_join
L_helper:
    v_subrev_u32 v2, 640, v0
    v_and_b32 v3, 63, v0
    v_mov_b32 v5, 0
    v_mov_b32 v6, 0
    v_mov_b32 v7, 0
    v_mov_b32 v9, 2500
    ds_write_b32 v22, v9 offset:1024
    s_mov_b32 s12, s56
    s_mov_b32 s13, s57
    s_mov_b32 s14, 5120000
    s_mov_b32 s15, 0x20000
    s_mov_b32 s16, s64
    s_mov_b32 s17, s65
    s_mov_b32 s18, 20480000
    s_mov_b32 s19, 0x20000
    s_mov_b32 s32, s72
    s_mov_b32 s33, s73
    s_mov_b32 s34, 5120000
    s_mov_b32 s35, 0x20000
    s_add_u32 s20, s10, 0x1000000
    s_addc_u32 s21, s11, 0
    s_mov_b32 s22, 7700480
    s_mov_b32 s23, 0x20000
    s_add_u32 s24, s10, 0x800000
    s_addc_u32 s25, s11, 0
    s_mov_b32 s26, 524288
    s_mov_b32 s27, 0x20000
    s_cmp_ge_u32 s39, 12
    s_cbranch_scc1 L_h_noprew
    v_lshlrev_b32 v9, 4, v2
    s_lshl_b32 s7, s2, 11
    buffer_store_dwordx4 v[4:7], v9, s[24:27], s7 offen sc1
L_h_noprew:
    v_lshlrev_b32 v8, 4, v2
    ds_write_b128 v8, v[4:7] offset:49664
    ds_write_b128 v8, v[4:7] offset:55808
    ds_write_b128 v8, v[4:7] offset:61952
    v_add_u32 v8, 68096, v8
    ds_write_b128 v8, v[4:7] offset:0
    ds_write_b128 v8, v[4:7] offset:6144
    ds_write_b128 v8, v[4:7] offset:12288
    ds_write_b128 v8, v[4:7] offset:18432
    ds_write_b128 v8, v[4:7] offset:24576
    ds_write_b128 v8, v[4:7] offset:30720
    ds_write_b128 v8, v[4:7] offset:36864
    ds_write_b128 v8, v[4:7] offset:43008
    s_barrier
    s_waitcnt lgkmcnt(0)
    s_barrier
    s_cmp_lg_u32 s39, 15
    s_cbranch_scc1 L_h_nopoll
    buffer_load_dwordx2 v[14:15], v4, s[28:31], 0 offen sc1
L_h_nopoll:
    s_cmp_eq_u32 s39, 10
    s_cbranch_scc1 L_h_w
    s_cmp_eq_u32 s39, 11
    s_cbranch_scc1 L_h_cg
    s_mov_b32 s40, s70
    s_mov_b32 s41, s71
    s_mov_b32 s42, 8192
    s_mov_b32 s43, 0x20000
    v_subrev_u32 v10, 12288, v46
    buffer_load_dwordx4 v[16:19], v10, s[40:43], 0 offen
    v_add_u32 v11, 4096, v10
    buffer_load_dwordx4 v[20:23], v11, s[40:43], 0 offen
    s_barrier
    s_cmp_lg_u32 s39, 15
    s_cbranch_scc1 L_h_mix
    s_mov_b32 s6, 0
    s_waitcnt vmcnt(2)
L_h_poll:
    v_readfirstlane_b32 s48, v15
    s_cmp_lg_u32 s48, 0
    s_cbranch_scc1 L_h_polled
    s_add_u32 s6, s6, 1
    s_cmp_ge_u32 s6, 262144
    s_cbranch_scc1 L_end
    buffer_load_dwordx2 v[14:15], v4, s[28:31], 0 offen sc1
    s_waitcnt vmcnt(0)
    s_branch L_h_poll
L_h_polled:
    v_mov_b32 v12, 135184
    v_and_b32 v15, 0xff, v15
    ds_write_b64 v12, v[14:15]
L_h_mix:
    v_lshrrev_b32 v4, 7, v10
    v_mul_u32_u24 v5, 144, v4
    v_and_b32 v6, 7, v3
    v_lshl_add_u32 v5, v6, 3, v5
    v_add_u32 v5, 136384, v5
    s_mov_b32 s8, 0x05040100
    s_mov_b32 s9, 0x07060302
    s_waitcnt vmcnt(0)
    v_perm_b32 v24, v17, v16, s8
    v_perm_b32 v25, v19, v18, s8
    v_perm_b32 v26, v17, v16, s9
    v_perm_b32 v27, v19, v18, s9
    ds_write_b64 v5, v[24:25] offset:0
    ds_write_b64 v5, v[26:27] offset:64
    v_perm_b32 v28, v21, v20, s8
    v_perm_b32 v29, v23, v22, s8
    v_perm_b32 v30, v21, v20, s9
    v_perm_b32 v31, v23, v22, s9
    ds_write_b64 v5, v[28:29] offset:4608
    ds_write_b64 v5, v[30:31] offset:4672
    s_branch L_join
L_h_cg:
    s_mov_b32 s40, s68
    s_mov_b32 s41, s69
    s_mov_b32 s42, 128
    s_mov_b32 s43, 0x20000
    v_and_b32 v10, 3, v3
    v_lshlrev_b32 v10, 1, v10
    buffer_load_ushort v16, v10, s[40:43], 0 offen offset:0
    buffer_load_ushort v17, v10, s[40:43], 0 offen offset:8
    buffer_load_ushort v18, v10, s[40:43], 0 offen offset:16
    buffer_load_ushort v19, v10, s[40:43], 0 offen offset:24
    buffer_load_ushort v20, v10, s[40:43], 0 offen offset:32
    buffer_load_ushort v21, v10, s[40:43], 0 offen offset:40
    buffer_load_ushort v22, v10, s[40:43], 0 offen offset:48
    buffer_load_ushort v23, v10, s[40:43], 0 offen offset:56
    buffer_load_ushort v24, v10, s[40:43], 0 offen offset:64
    buffer_load_ushort v25, v10, s[40:43], 0 offen offset:72
    buffer_load_ushort v26, v10, s[40:43], 0 offen offset:80
    buffer_load_ushort v27, v10, s[40:43], 0 offen offset:88
    buffer_load_ushort v28, v10, s[40:43], 0 offen offset:96
    buffer_load_ushort v29, v10, s[40:43], 0 offen offset:104
    buffer_load_ushort v30, v10, s[40:43], 0 offen offset:112
    buffer_load_ushort v31, v10, s[40:43], 0 offen offset:120
    v_lshlrev_b32 v9, 4, v3
    v_add_u32 v9, 147648, v9
    s_barrier
    s_waitcnt vmcnt(0)
    v_lshl_or_b32 v32, v17, 16, v16
    v_lshl_or_b32 v33, v19, 16, v18
    v_lshl_or_b32 v34, v21, 16, v20
    v_lshl_or_b32 v35, v23, 16, v22
    v_lshl_or_b32 v36, v25, 16, v24
    v_lshl_or_b32 v37, v27, 16, v26
    v_lshl_or_b32 v38, v29, 16, v28
    v_lshl_or_b32 v39, v31, 16, v30
    ds_write_b128 v9, v[32:35]
    ds_write_b128 v9, v[36:39] offset:1024
    s_branch L_join
L_h_w:
    s_mov_b32 s40, s66
    s_mov_b32 s41, s67
    s_mov_b32 s42, 2048
    s_mov_b32 s43, 0x20000
    v_lshrrev_b32 v10, 5, v3
    v_lshlrev_b32 v10, 10, v10
    v_and_b32 v11, 31, v3
    v_lshl_add_u32 v10, v11, 2, v10
    buffer_load_dword v16, v10, s[40:43], 0 offen offset:0
    buffer_load_dword v17, v10, s[40:43], 0 offen offset:128
    buffer_load_dword v18, v10, s[40:43], 0 offen offset:256
    buffer_load_dword v19, v10, s[40:43], 0 offen offset:384
    buffer_load_dword v20, v10, s[40:43], 0 offen offset:512
    buffer_load_dword v21, v10, s[40:43], 0 offen offset:640
    buffer_load_dword v22, v10, s[40:43], 0 offen offset:768
    buffer_load_dword v23, v10, s[40:43], 0 offen offset:896
    v_lshlrev_b32 v9, 4, v3
    v_add_u32 v9, 145600, v9
    s_mov_b32 s8, 0xbfb8aa3b
    s_barrier
    s_waitcnt vmcnt(0)
    v_lshlrev_b32 v24, 16, v16
    v_and_b32 v32, 0xffff0000, v16
    v_mul_f32 v24, s8, v24
    v_mul_f32 v32, s8, v32
    v_lshlrev_b32 v25, 16, v17
    v_and_b32 v33, 0xffff0000, v17
    v_mul_f32 v25, s8, v25
    v_mul_f32 v33, s8, v33
    v_lshlrev_b32 v26, 16, v18
    v_and_b32 v34, 0xffff0000, v18
    v_mul_f32 v26, s8, v26
    v_mul_f32 v34, s8, v34
    v_lshlrev_b32 v27, 16, v19
    v_and_b32 v35, 0xffff0000, v19
    v_mul_f32 v27, s8, v27
    v_mul_f32 v35, s8, v35
    v_lshlrev_b32 v28, 16, v20
    v_and_b32 v36, 0xffff0000, v20
    v_mul_f32 v28, s8, v28
    v_mul_f32 v36, s8, v36
    v_lshlrev_b32 v29, 16, v21
    v_and_b32 v37, 0xffff0000, v21
    v_mul_f32 v29, s8, v29
    v_mul_f32 v37, s8, v37
    v_lshlrev_b32 v30, 16, v22
    v_and_b32 v38, 0xffff0000, v22
    v_mul_f32 v30, s8, v30
    v_mul_f32 v38, s8, v38
    v_lshlrev_b32 v31, 16, v23
    v_and_b32 v39, 0xffff0000, v23
    v_mul_f32 v31, s8, v31
    v_mul_f32 v39, s8, v39
    v_cvt_pk_bf16_f32 v16, v24, v25
    v_cvt_pk_bf16_f32 v17, v26, v27
    v_cvt_pk_bf16_f32 v18, v28, v29
    v_cvt_pk_bf16_f32 v19, v30, v31
    v_cvt_pk_bf16_f32 v20, v32, v33
    v_cvt_pk_bf16_f32 v21, v34, v35
    v_cvt_pk_bf16_f32 v22, v36, v37
    v_cvt_pk_bf16_f32 v23, v38, v39
    ds_write_b128 v9, v[16:19]
    ds_write_b128 v9, v[20:23] offset:1024
L_join:
    s_waitcnt lgkmcnt(0)
    s_barrier
    v_and_b32 v80, 63, v0
    v_lshlrev_b32 v81, 4, v80
    v_add_u32 v81, 145600, v81
    v_mov_b32 v82, 135184
    ds_read_b64 v[44:45], v82
    ds_read_b128 v[2:5], v81 offset:0
    ds_read_b128 v[6:9], v81 offset:1024
    ds_read_b128 v[10:13], v81 offset:2048
    ds_read_b128 v[14:17], v81 offset:3072
    s_and_b32 s36, s2, 7
    s_lshl_b32 s36, s36, 5
    s_lshr_b32 s3, s2, 3
    s_add_u32 s36, s36, s3
    s_mul_i32 s37, s36, 625
    s_add_u32 s38, s37, 640
    s_add_u32 s37, s37, 15
    s_lshr_b32 s37, s37, 4
    s_lshr_b32 s38, s38, 4
    s_mov_b32 s40, 0
    s_mov_b32 s41, 0
    s_mov_b32 s42, 0
    s_mov_b32 s73, 1
    s_mov_b32 s72, 6711
    s_mov_b32 s50, 0x1ffffff
    v_and_b32 v83, 31, v80
    v_lshlrev_b32 v1, 4, v83
    v_lshlrev_b32 v18, 3, v80
    v_add_u32 v18, 49664, v18
    v_lshrrev_b32 v22, 5, v80
    v_mul_u32_u24 v19, 6208, v22
    v_and_b32 v83, 15, v80
    v_lshl_add_u32 v19, v83, 2, v19
    v_mul_u32_u24 v21, 1552, v22
    v_lshlrev_b32 v22, 4, v22
    v_lshl_add_u32 v23, v1, 1, v22
    v_add_u32 v23, 145600, v23
    v_bfe_u32 v20, v80, 2, 1
    v_mul_u32_u24 v20, 1552, v20
    v_bfe_u32 v83, v80, 3, 2
    v_lshl_add_u32 v20, v83, 2, v20
    v_and_b32 v83, 3, v80
    v_add_lshl_u32 v20, v20, v83, 2
    v_and_b32 v83, 1, v80
    v_lshl_add_u32 v21, v83, 3, v21
    v_bfe_u32 v83, v80, 2, 3
    v_add_lshl_u32 v21, v21, v83, 3
    s_waitcnt lgkmcnt(0)
    v_readfirstlane_b32 s5, v44
    v_readfirstlane_b32 s4, v45
    v_lshl_or_b32 v42, v45, 24, v42
    v_lshl_or_b32 v40, v45, 24, v40
    v_mov_b32 v41, v44
    v_mov_b32 v43, v44
L_round:
    v_lshrrev_b32 v86, 4, v0
    v_and_b32 v87, 3, v0
    v_lshl_add_u32 v88, v87, 6, v86
    s_lshl_b32 s3, s36, 3
    v_lshl_add_u32 v26, v88, 11, s3
    v_and_b32 v87, s42, v87
    v_cmp_eq_u32 s[74:75], s41, v87
    s_mov_b32 s8, 0x000f000f
    s_mov_b32 s9, 0x000f000f
    v_mov_b32 v96, 1
    v_mov_b32 v99, 135232
    v_and_b32 v97, 15, v0
    s_lshl_b32 s71, s40, 5
    v_add_u32 v97, s71, v97
    s_add_u32 s71, s71, 32
    v_add_u32 v98, 16, v97
    v_mul_u32_u24 v100, 2500, v86
    v_mul_u32_u24 v28, 30080, v86
    v_mad_u32_u24 v28, v97, 12, v28
    v_add_u32 v101, 160000, v100
    v_add_u32 v29, 1925120, v28
    v_add_u32 v102, 320000, v100
    v_add_u32 v30, 3850240, v28
    v_add_u32 v103, 480000, v100
    v_add_u32 v31, 5775360, v28
    s_mov_b32 s6, 0
    s_mov_b32 s68, 15
    s_mov_b32 s69, 0
    s_lshl_b32 s7, s2, 11
    s_mul_i32 s3, s2, 123
    v_subrev_u32 v88, 128, v0
    v_min_u32 v88, 122, v88
    v_add_lshl_u32 v88, v88, s3, 7
    s_waitcnt vmcnt(0) lgkmcnt(0)
    s_barrier
    s_cmp_eq_u32 s73, 0
    s_cbranch_scc1 L_nofirst
    s_mov_b32 s73, 0
    s_cmp_ge_u32 s39, 2
    s_cbranch_scc1 L_notab
    buffer_store_dwordx4 v[40:43], v46, s[24:27], s7 offen sc1
L_notab:
    v_lshlrev_b32 v84, 4, v0
    v_mov_b32 v80, 0x0
    v_mov_b32 v81, 0x0
    v_mov_b32 v82, 0x0
    v_mov_b32 v83, 0x0
    v_add_u32 v84, 117248, v84
    ds_write_b128 v84, v[80:83] offset:0
    v_cmp_gt_u32 vcc, 32, v0
    s_and_saveexec_b64 s[48:49], vcc
    s_cbranch_execz L_fill1
    ds_write_b128 v84, v[80:83] offset:16384
L_fill1:
    s_mov_b64 exec, s[48:49]
    s_sub_u32 s48, s39, 2
    s_cmp_ge_u32 s48, 2
    s_cbranch_scc1 L_nopf
    buffer_load_dword v115, v88, s[12:15], 0 offen
L_nopf:
L_nofirst:
    v_lshlrev_b32 v84, 4, v0
    v_mov_b32 v80, 0x0
    v_mov_b32 v81, 0x0
    v_mov_b32 v82, 0x0
    v_mov_b32 v83, 0x0
    v_add_u32 v84, 135232, v84
    v_cmp_gt_u32 vcc, 72, v0
    s_and_saveexec_b64 s[48:49], vcc
    s_cbranch_execz L_fill2
    ds_write_b128 v84, v[80:83] offset:0
L_fill2:
    s_mov_b64 exec, s[48:49]
    v_lshlrev_b32 v84, 4, v0
    ds_write_b128 v84, v[80:83] offset:24832
    v_cmp_gt_u32 vcc, 528, v0
    s_and_saveexec_b64 s[48:49], vcc
    s_cbranch_execz L_fill3
    ds_write_b128 v84, v[80:83] offset:41216
L_fill3:
    s_mov_b64 exec, s[48:49]
    v_lshlrev_b32 v84, 4, v0
    v_mov_b32 v80, 0x7fff0000
    v_mov_b32 v81, 0x7fff0000
    v_mov_b32 v82, 0x7fff0000
    v_mov_b32 v83, 0x7fff0000
    v_cmp_gt_u32 vcc, 776, v0
    s_and_saveexec_b64 s[48:49], vcc
    s_cbranch_execz L_fill4
    ds_write_b128 v84, v[80:83] offset:0
L_fill4:
    s_mov_b64 exec, s[48:49]
    v_lshlrev_b32 v84, 4, v0
    v_mov_b32 v80, 0x1ffffe0
    v_mov_b32 v81, 0x1ffffe0
    v_mov_b32 v82, 0x1ffffe0
    v_mov_b32 v83, 0x1ffffe0
    v_cmp_gt_u32 vcc, 776, v0
    s_and_saveexec_b64 s[48:49], vcc
    s_cbranch_execz L_fill5
    ds_write_b128 v84, v[80:83] offset:12416
L_fill5:
    s_mov_b64 exec, s[48:49]
    s_waitcnt lgkmcnt(0)
    s_barrier
    s_mov_b64 exec, s[8:9]
    buffer_load_dwordx2 v[24:25], v26, s[24:27], 0 offen sc1
    s_mov_b64 exec, -1
L_poll:
    s_mov_b32 s70, 0
    s_cmp_eq_u32 s68, 0
    s_waitcnt vmcnt(0)
    s_cbranch_scc1 L_ranks
    v_lshrrev_b32 v80, 24, v24
    v_cmp_ne_u32 s[48:49], s5, v25
    v_cmp_ne_u32 vcc, s4, v80
    v_bfe_u32 v83, v24, 12, 12
    v_and_b32 v84, 0xfff, v24
    v_cndmask_b32 v83, 0, v83, s[74:75]
    v_mul_u32_u24 v84, 12, v84
    s_or_b64 vcc, vcc, s[48:49]
    s_and_b64 s[8:9], s[8:9], vcc
    s_or_b32 s48, s8, s9
    s_lshr_b32 s49, s48, 16
    s_or_b32 s48, s48, s49
    s_andn2_b32 s70, s68, s48
    s_and_b32 s68, s68, s48
    s_cmp_eq_u32 s70, 15
    s_cbranch_scc1 L_fast
    s_bitcmp0_b32 s70, 0
    s_cbranch_scc1 L_is0
    v_mov_b32_dpp v80, v83 row_newbcast:0 row_mask:0xf bank_mask:0xf
    v_add_u32_dpp v28, v84, v28 row_newbcast:0 row_mask:0xf bank_mask:0xf
    v_cmp_lt_u32 s[52:53], v97, v80
    v_cmp_lt_u32 s[54:55], v98, v80
    s_mov_b64 exec, s[52:53]
    s_cbranch_execz L_it0
    buffer_load_dwordx4 v[32:35], v28, s[20:23], 0 offen sc1
    s_mov_b64 exec, s[54:55]
    s_cbranch_execz L_it0
    buffer_load_dwordx4 v[36:39], v28, s[20:23], 0 offen offset:192 sc1
L_it0:
    s_mov_b64 exec, -1
L_is0:
    s_bitcmp0_b32 s70, 1
    s_cbranch_scc1 L_is1
    v_mov_b32_dpp v80, v83 row_newbcast:1 row_mask:0xf bank_mask:0xf
    v_add_u32_dpp v29, v84, v29 row_newbcast:1 row_mask:0xf bank_mask:0xf
    v_cmp_lt_u32 s[56:57], v97, v80
    v_cmp_lt_u32 s[58:59], v98, v80
    s_mov_b64 exec, s[56:57]
    s_cbranch_execz L_it1
    buffer_load_dwordx4 v[40:43], v29, s[20:23], 0 offen sc1
    s_mov_b64 exec, s[58:59]
    s_cbranch_execz L_it1
    buffer_load_dwordx4 v[44:47], v29, s[20:23], 0 offen offset:192 sc1
L_it1:
    s_mov_b64 exec, -1
L_is1:
    s_bitcmp0_b32 s70, 2
    s_cbranch_scc1 L_is2
    v_mov_b32_dpp v80, v83 row_newbcast:2 row_mask:0xf bank_mask:0xf
    v_add_u32_dpp v30, v84, v30 row_newbcast:2 row_mask:0xf bank_mask:0xf
    v_cmp_lt_u32 s[60:61], v97, v80
    v_cmp_lt_u32 s[62:63], v98, v80
    s_mov_b64 exec, s[60:61]
    s_cbranch_execz L_it2
    buffer_load_dwordx4 v[48:51], v30, s[20:23], 0 offen sc1
    s_mov_b64 exec, s[62:63]
    s_cbranch_execz L_it2
    buffer_load_dwordx4 v[52:55], v30, s[20:23], 0 offen offset:192 sc1
L_it2:
    s_mov_b64 exec, -1
L_is2:
    s_bitcmp0_b32 s70, 3
    s_cbranch_scc1 L_is3
    v_mov_b32_dpp v80, v83 row_newbcast:3 row_mask:0xf bank_mask:0xf
    v_add_u32_dpp v31, v84, v31 row_newbcast:3 row_mask:0xf bank_mask:0xf
    v_cmp_lt_u32 s[64:65], v97, v80
    v_cmp_lt_u32 s[66:67], v98, v80
    s_mov_b64 exec, s[64:65]
    s_cbranch_execz L_it3
    buffer_load_dwordx4 v[56:59], v31, s[20:23], 0 offen sc1
    s_mov_b64 exec, s[66:67]
    s_cbranch_execz L_it3
    buffer_load_dwordx4 v[60:63], v31, s[20:23], 0 offen offset:192 sc1
L_it3:
    s_mov_b64 exec, -1
L_is3:
    s_cmp_eq_u32 s68, 0
    s_cbranch_scc1 L_ranks
    s_add_u32 s6, s6, 1
    s_cmp_ge_u32 s6, 262144
    s_cbranch_scc1 L_end
    s_mov_b64 exec, s[8:9]
    buffer_load_dwordx2 v[24:25], v26, s[24:27], 0 offen sc1
    s_mov_b64 exec, -1
L_ranks:
    s_bitcmp0_b32 s69, 0
    s_cbranch_scc1 L_rs0
    s_mov_b64 exec, s[52:53]
    v_bfe_u32 v81, v34, 14, 6
    v_and_b32 v80, 0x3fff, v34
    v_mul_u32_u24 v82, s72, v80
    v_lshrrev_b32 v82, 24, v82
    v_mad_u32_u24 v82, v82, 40, v81
    v_lshl_add_u32 v72, v82, 2, v99
    ds_add_rtn_u32 v64, v72, v96
    v_lshrrev_b32 v35, 20, v34
    v_add_lshl_u32 v85, v35, v100, 5
    v_lshl_or_b32 v35, v81, 25, v85
    v_lshlrev_b32 v34, 9, v80
    s_mov_b64 exec, s[54:55]
    s_cbranch_execz L_rk0
    v_bfe_u32 v81, v38, 14, 6
    v_and_b32 v80, 0x3fff, v38
    v_mul_u32_u24 v82, s72, v80
    v_lshrrev_b32 v82, 24, v82
    v_mad_u32_u24 v82, v82, 40, v81
    v_lshl_add_u32 v73, v82, 2, v99
    ds_add_rtn_u32 v65, v73, v96
    v_lshrrev_b32 v39, 20, v38
    v_add_lshl_u32 v85, v39, v100, 5
    v_lshl_or_b32 v39, v81, 25, v85
    v_lshlrev_b32 v38, 9, v80
L_rk0:
    s_mov_b64 exec, -1
L_rs0:
    s_bitcmp0_b32 s69, 1
    s_cbranch_scc1 L_rs1
    s_mov_b64 exec, s[56:57]
    v_bfe_u32 v81, v42, 14, 6
    v_and_b32 v80, 0x3fff, v42
    v_mul_u32_u24 v82, s72, v80
    v_lshrrev_b32 v82, 24, v82
    v_mad_u32_u24 v82, v82, 40, v81
    v_lshl_add_u32 v74, v82, 2, v99
    ds_add_rtn_u32 v66, v74, v96
    v_lshrrev_b32 v43, 20, v42
    v_add_lshl_u32 v85, v43, v101, 5
    v_lshl_or_b32 v43, v81, 25, v85
    v_lshlrev_b32 v42, 9, v80
    s_mov_b64 exec, s[58:59]
    s_cbranch_execz L_rk1
    v_bfe_u32 v81, v46, 14, 6
    v_and_b32 v80, 0x3fff, v46
    v_mul_u32_u24 v82, s72, v80
    v_lshrrev_b32 v82, 24, v82
    v_mad_u32_u24 v82, v82, 40, v81
    v_lshl_add_u32 v75, v82, 2, v99
    ds_add_rtn_u32 v67, v75, v96
    v_lshrrev_b32 v47, 20, v46
    v_add_lshl_u32 v85, v47, v101, 5
    v_lshl_or_b32 v47, v81, 25, v85
    v_lshlrev_b32 v46, 9, v80
L_rk1:
    s_mov_b64 exec, -1
L_rs1:
    s_bitcmp0_b32 s69, 2
    s_cbranch_scc1 L_rs2
    s_mov_b64 exec, s[60:61]
    v_bfe_u32 v81, v50, 14, 6
    v_and_b32 v80, 0x3fff, v50
    v_mul_u32_u24 v82, s72, v80
    v_lshrrev_b32 v82, 24, v82
    v_mad_u32_u24 v82, v82, 40, v81
    v_lshl_add_u32 v76, v82, 2, v99
    ds_add_rtn_u32 v68, v76, v96
    v_lshrrev_b32 v51, 20, v50
    v_add_lshl_u32 v85, v51, v102, 5
    v_lshl_or_b32 v51, v81, 25, v85
    v_lshlrev_b32 v50, 9, v80
    s_mov_b64 exec, s[62:63]
    s_cbranch_execz L_rk2
    v_bfe_u32 v81, v54, 14, 6
    v_and_b32 v80, 0x3fff, v54
    v_mul_u32_u24 v82, s72, v80
    v_lshrrev_b32 v82, 24, v82
    v_mad_u32_u24 v82, v82, 40, v81
    v_lshl_add_u32 v77, v82, 2, v99
    ds_add_rtn_u32 v69, v77, v96
    v_lshrrev_b32 v55, 20, v54
    v_add_lshl_u32 v85, v55, v102, 5
    v_lshl_or_b32 v55, v81, 25, v85
    v_lshlrev_b32 v54, 9, v80
L_rk2:
    s_mov_b64 exec, -1
L_rs2:
    s_bitcmp0_b32 s69, 3
    s_cbranch_scc1 L_rs3
    s_mov_b64 exec, s[64:65]
    v_bfe_u32 v81, v58, 14, 6
    v_and_b32 v80, 0x3fff, v58
    v_mul_u32_u24 v82, s72, v80
    v_lshrrev_b32 v82, 24, v82
    v_mad_u32_u24 v82, v82, 40, v81
    v_lshl_add_u32 v78, v82, 2, v99
    ds_add_rtn_u32 v70, v78, v96
    v_lshrrev_b32 v59, 20, v58
    v_add_lshl_u32 v85, v59, v103, 5
    v_lshl_or_b32 v59, v81, 25, v85
    v_lshlrev_b32 v58, 9, v80
    s_mov_b64 exec, s[66:67]
    s_cbranch_execz L_rk3
    v_bfe_u32 v81, v62, 14, 6
    v_and_b32 v80, 0x3fff, v62
    v_mul_u32_u24 v82, s72, v80
    v_lshrrev_b32 v82, 24, v82
    v_mad_u32_u24 v82, v82, 40, v81
    v_lshl_add_u32 v79, v82, 2, v99
    ds_add_rtn_u32 v71, v79, v96
    v_lshrrev_b32 v63, 20, v62
    v_add_lshl_u32 v85, v63, v103, 5
    v_lshl_or_b32 v63, v81, 25, v85
    v_lshlrev_b32 v62, 9, v80
L_rk3:
    s_mov_b64 exec, -1
L_rs3:
    s_mov_b32 s69, s70
    s_or_b32 s48, s68, s69
    s_cbranch_scc1 L_poll
    s_branch L_ranked
L_fast:
    v_mov_b32_dpp v88, v83 row_newbcast:0 row_mask:0xf bank_mask:0xf
    v_add_u32_dpp v28, v84, v28 row_newbcast:0 row_mask:0xf bank_mask:0xf
    v_cmp_lt_u32 s[52:53], v97, v88
    v_mov_b32_dpp v89, v83 row_newbcast:1 row_mask:0xf bank_mask:0xf
    v_add_u32_dpp v29, v84, v29 row_newbcast:1 row_mask:0xf bank_mask:0xf
    v_cmp_lt_u32 s[56:57], v97, v89
    v_mov_b32_dpp v90, v83 row_newbcast:2 row_mask:0xf bank_mask:0xf
    v_add_u32_dpp v30, v84, v30 row_newbcast:2 row_mask:0xf bank_mask:0xf
    v_cmp_lt_u32 s[60:61], v97, v90
    v_mov_b32_dpp v91, v83 row_newbcast:3 row_mask:0xf bank_mask:0xf
    v_add_u32_dpp v31, v84, v31 row_newbcast:3 row_mask:0xf bank_mask:0xf
    v_cmp_lt_u32 s[64:65], v97, v91
    s_mov_b64 exec, s[52:53]
    s_cbranch_execz L_fe0
    buffer_load_dwordx4 v[32:35], v28, s[20:23], 0 offen sc1
L_fe0:
    s_mov_b64 exec, s[56:57]
    s_cbranch_execz L_fe1
    buffer_load_dwordx4 v[40:43], v29, s[20:23], 0 offen sc1
L_fe1:
    s_mov_b64 exec, s[60:61]
    s_cbranch_execz L_fe2
    buffer_load_dwordx4 v[48:51], v30, s[20:23], 0 offen sc1
L_fe2:
    s_mov_b64 exec, s[64:65]
    s_cbranch_execz L_fe3
    buffer_load_dwordx4 v[56:59], v31, s[20:23], 0 offen sc1
L_fe3:
    s_mov_b64 exec, -1
    v_cmp_lt_u32 s[54:55], v98, v88
    v_cmp_lt_u32 s[58:59], v98, v89
    v_cmp_lt_u32 s[62:63], v98, v90
    v_cmp_lt_u32 s[66:67], v98, v91
    s_or_b64 s[8:9], s[54:55], s[58:59]
    s_or_b64 s[8:9], s[8:9], s[62:63]
    s_or_b64 s[8:9], s[8:9], s[66:67]
    s_cbranch_scc0 L_f_nosecond
    s_mov_b64 exec, s[54:55]
    s_cbranch_execz L_fs0
    buffer_load_dwordx4 v[36:39], v28, s[20:23], 0 offen offset:192 sc1
L_fs0:
    s_mov_b64 exec, s[58:59]
    s_cbranch_execz L_fs1
    buffer_load_dwordx4 v[44:47], v29, s[20:23], 0 offen offset:192 sc1
L_fs1:
    s_mov_b64 exec, s[62:63]
    s_cbranch_execz L_fs2
    buffer_load_dwordx4 v[52:55], v30, s[20:23], 0 offen offset:192 sc1
L_fs2:
    s_mov_b64 exec, s[66:67]
    s_cbranch_execz L_fs3
    buffer_load_dwordx4 v[60:63], v31, s[20:23], 0 offen offset:192 sc1
L_fs3:
L_f_nosecond:
    s_cmp_eq_u64 s[8:9], 0
    s_waitcnt vmcnt(0)
    s_mov_b64 exec, s[52:53]
    v_bfe_u32 v81, v34, 14, 6
    v_and_b32 v80, 0x3fff, v34
    v_mul_u32_u24 v82, s72, v80
    v_lshrrev_b32 v82, 24, v82
    v_mad_u32_u24 v82, v82, 40, v81
    v_lshl_add_u32 v72, v82, 2, v99
    ds_add_rtn_u32 v64, v72, v96
    v_lshrrev_b32 v35, 20, v34
    v_add_lshl_u32 v85, v35, v100, 5
    v_lshl_or_b32 v35, v81, 25, v85
    v_lshlrev_b32 v34, 9, v80
    s_mov_b64 exec, s[56:57]
    v_bfe_u32 v81, v42, 14, 6
    v_and_b32 v80, 0x3fff, v42
    v_mul_u32_u24 v82, s72, v80
    v_lshrrev_b32 v82, 24, v82
    v_mad_u32_u24 v82, v82, 40, v81
    v_lshl_add_u32 v74, v82, 2, v99
    ds_add_rtn_u32 v66, v74, v96
    v_lshrrev_b32 v43, 20, v42
    v_add_lshl_u32 v85, v43, v101, 5
    v_lshl_or_b32 v43, v81, 25, v85
    v_lshlrev_b32 v42, 9, v80
    s_mov_b64 exec, s[60:61]
    v_bfe_u32 v81, v50, 14, 6
    v_and_b32 v80, 0x3fff, v50
    v_mul_u32_u24 v82, s72, v80
    v_lshrrev_b32 v82, 24, v82
    v_mad_u32_u24 v82, v82, 40, v81
    v_lshl_add_u32 v76, v82, 2, v99
    ds_add_rtn_u32 v68, v76, v96
    v_lshrrev_b32 v51, 20, v50
    v_add_lshl_u32 v85, v51, v102, 5
    v_lshl_or_b32 v51, v81, 25, v85
    v_lshlrev_b32 v50, 9, v80
    s_mov_b64 exec, s[64:65]
    v_bfe_u32 v81, v58, 14, 6
    v_and_b32 v80, 0x3fff, v58
    v_mul_u32_u24 v82, s72, v80
    v_lshrrev_b32 v82, 24, v82
    v_mad_u32_u24 v82, v82, 40, v81
    v_lshl_add_u32 v78, v82, 2, v99
    ds_add_rtn_u32 v70, v78, v96
    v_lshrrev_b32 v59, 20, v58
    v_add_lshl_u32 v85, v59, v103, 5
    v_lshl_or_b32 v59, v81, 25, v85
    v_lshlrev_b32 v58, 9, v80
    s_cbranch_scc1 L_f_done
    s_mov_b64 exec, s[54:55]
    s_cbranch_execz L_fg0
    v_bfe_u32 v81, v38, 14, 6
    v_and_b32 v80, 0x3fff, v38
    v_mul_u32_u24 v82, s72, v80
    v_lshrrev_b32 v82, 24, v82
    v_mad_u32_u24 v82, v82, 40, v81
    v_lshl_add_u32 v73, v82, 2, v99
    ds_add_rtn_u32 v65, v73, v96
    v_lshrrev_b32 v39, 20, v38
    v_add_lshl_u32 v85, v39, v100, 5
    v_lshl_or_b32 v39, v81, 25, v85
    v_lshlrev_b32 v38, 9, v80
L_fg0:
    s_mov_b64 exec, s[58:59]
    s_cbranch_execz L_fg1
    v_bfe_u32 v81, v46, 14, 6
    v_and_b32 v80, 0x3fff, v46
    v_mul_u32_u24 v82, s72, v80
    v_lshrrev_b32 v82, 24, v82
    v_mad_u32_u24 v82, v82, 40, v81
    v_lshl_add_u32 v75, v82, 2, v99
    ds_add_rtn_u32 v67, v75, v96
    v_lshrrev_b32 v47, 20, v46
    v_add_lshl_u32 v85, v47, v101, 5
    v_lshl_or_b32 v47, v81, 25, v85
    v_lshlrev_b32 v46, 9, v80
L_fg1:
    s_mov_b64 exec, s[62:63]
    s_cbranch_execz L_fg2
    v_bfe_u32 v81, v54, 14, 6
    v_and_b32 v80, 0x3fff, v54
    v_mul_u32_u24 v82, s72, v80
    v_lshrrev_b32 v82, 24, v82
    v_mad_u32_u24 v82, v82, 40, v81
    v_lshl_add_u32 v77, v82, 2, v99
    ds_add_rtn_u32 v69, v77, v96
    v_lshrrev_b32 v55, 20, v54
    v_add_lshl_u32 v85, v55, v102, 5
    v_lshl_or_b32 v55, v81, 25, v85
    v_lshlrev_b32 v54, 9, v80
L_fg2:
    s_mov_b64 exec, s[66:67]
    s_cbranch_execz L_fg3
    v_bfe_u32 v81, v62, 14, 6
    v_and_b32 v80, 0x3fff, v62
    v_mul_u32_u24 v82, s72, v80
    v_lshrrev_b32 v82, 24, v82
    v_mad_u32_u24 v82, v82, 40, v81
    v_lshl_add_u32 v79, v82, 2, v99
    ds_add_rtn_u32 v71, v79, v96
    v_lshrrev_b32 v63, 20, v62
    v_add_lshl_u32 v85, v63, v103, 5
    v_lshl_or_b32 v63, v81, 25, v85
    v_lshlrev_b32 v62, 9, v80
L_fg3:
L_f_done:
    s_mov_b64 exec, -1
L_ranked:
    v_bfe_u32 v83, v24, 12, 12
    v_cmp_lt_u32 vcc, s71, v83
    s_or_b32 s48, vcc_lo, vcc_hi
    s_and_b32 s48, s48, 0x000f000f
    s_cbranch_scc0 L_nomore
    v_mov_b32 v80, 136264
    ds_write_b32 v80, v96
L_nomore:
    s_movk_i32 s48, 6206
    s_brev_b32 s49, 1
    s_waitcnt lgkmcnt(0)
    s_barrier
    s_cmp_lg_u32 s39, 0
    s_cbranch_scc1 L_noscan
    v_lshl_add_u32 v89, v0, 4, v99
    ds_read_b128 v[80:83], v89
    s_waitcnt lgkmcnt(0)
    v_add_lshl_u32 v80, v80, 1, 1
    v_and_b32 v80, -4, v80
    v_add_lshl_u32 v81, v81, 1, 1
    v_and_b32 v81, -4, v81
    v_add_lshl_u32 v82, v82, 1, 1
    v_and_b32 v82, -4, v82
    v_add_lshl_u32 v83, v83, 1, 1
    v_and_b32 v83, -4, v83
    v_add_u32 v85, v80, v81
    v_add_u32 v86, v85, v82
    v_add_u32 v87, v86, v83
    v_mov_b32 v88, v87
    s_nop 0
    v_add_u32_dpp v87, v87, v87 row_shr:1
    s_nop 1
    v_add_u32_dpp v87, v87, v87 row_shr:2
    s_nop 1
    v_add_u32_dpp v87, v87, v87 row_shr:4
    s_nop 1
    v_add_u32_dpp v87, v87, v87 row_shr:8
    s_nop 1
    v_add_u32_dpp v87, v87, v87 row_bcast:15 row_mask:0xa
    s_nop 1
    v_add_u32_dpp v87, v87, v87 row_bcast:31 row_mask:0xc
    v_sub_u32 v84, v87, v88
    v_add_u32 v87, v84, v86
    v_add_u32 v86, v84, v85
    v_add_u32 v85, v84, v80
    ds_write_b128 v89, v[84:87]
L_noscan:
    s_mov_b64 exec, s[52:53]
    v_add_u32 v90, -1, v64
    v_and_or_b32 v35, v90, s49, v35
    v_and_b32 v90, 1, v64
    v_lshlrev_b32 v64, 1, v64
    v_mad_u32_u24 v64, v90, s48, v64
    v_cmp_gt_u32 vcc, 135304, v72
    v_and_b32 v90, s50, v35
    s_and_b64 exec, exec, vcc
    s_cbranch_execz L_eft0
    buffer_load_dword v115, v90, s[16:19], 0 offen
L_eft0:
    s_mov_b64 exec, s[54:55]
    s_cbranch_execz L_pr0
    v_add_u32 v90, -1, v65
    v_and_or_b32 v39, v90, s49, v39
    v_and_b32 v90, 1, v65
    v_lshlrev_b32 v65, 1, v65
    v_mad_u32_u24 v65, v90, s48, v65
    v_cmp_gt_u32 vcc, 135304, v73
    v_and_b32 v90, s50, v39
    s_and_b64 exec, exec, vcc
    s_cbranch_execz L_eft1
    buffer_load_dword v115, v90, s[16:19], 0 offen
L_eft1:
L_pr0:
    s_mov_b64 exec, s[56:57]
    v_add_u32 v90, -1, v66
    v_and_or_b32 v43, v90, s49, v43
    v_and_b32 v90, 1, v66
    v_lshlrev_b32 v66, 1, v66
    v_mad_u32_u24 v66, v90, s48, v66
    v_cmp_gt_u32 vcc, 135304, v74
    v_and_b32 v90, s50, v43
    s_and_b64 exec, exec, vcc
    s_cbranch_execz L_eft2
    buffer_load_dword v115, v90, s[16:19], 0 offen
L_eft2:
    s_mov_b64 exec, s[58:59]
    s_cbranch_execz L_pr1
    v_add_u32 v90, -1, v67
    v_and_or_b32 v47, v90, s49, v47
    v_and_b32 v90, 1, v67
    v_lshlrev_b32 v67, 1, v67
    v_mad_u32_u24 v67, v90, s48, v67
    v_cmp_gt_u32 vcc, 135304, v75
    v_and_b32 v90, s50, v47
    s_and_b64 exec, exec, vcc
    s_cbranch_execz L_eft3
    buffer_load_dword v115, v90, s[16:19], 0 offen
L_eft3:
L_pr1:
    s_mov_b64 exec, s[60:61]
    v_add_u32 v90, -1, v68
    v_and_or_b32 v51, v90, s49, v51
    v_and_b32 v90, 1, v68
    v_lshlrev_b32 v68, 1, v68
    v_mad_u32_u24 v68, v90, s48, v68
    v_cmp_gt_u32 vcc, 135304, v76
    v_and_b32 v90, s50, v51
    s_and_b64 exec, exec, vcc
    s_cbranch_execz L_eft4
    buffer_load_dword v115, v90, s[16:19], 0 offen
L_eft4:
    s_mov_b64 exec, s[62:63]
    s_cbranch_execz L_pr2
    v_add_u32 v90, -1, v69
    v_and_or_b32 v55, v90, s49, v55
    v_and_b32 v90, 1, v69
    v_lshlrev_b32 v69, 1, v69
    v_mad_u32_u24 v69, v90, s48, v69
    v_cmp_gt_u32 vcc, 135304, v77
    v_and_b32 v90, s50, v55
    s_and_b64 exec, exec, vcc
    s_cbranch_execz L_eft5
    buffer_load_dword v115, v90, s[16:19], 0 offen
L_eft5:
L_pr2:
    s_mov_b64 exec, s[64:65]
    v_add_u32 v90, -1, v70
    v_and_or_b32 v59, v90, s49, v59
    v_and_b32 v90, 1, v70
    v_lshlrev_b32 v70, 1, v70
    v_mad_u32_u24 v70, v90, s48, v70
    v_cmp_gt_u32 vcc, 135304, v78
    v_and_b32 v90, s50, v59
    s_and_b64 exec, exec, vcc
    s_cbranch_execz L_eft6
    buffer_load_dword v115, v90, s[16:19], 0 offen
L_eft6:
    s_mov_b64 exec, s[66:67]
    s_cbranch_execz L_pr3
    v_add_u32 v90, -1, v71
    v_and_or_b32 v63, v90, s49, v63
    v_and_b32 v90, 1, v71
    v_lshlrev_b32 v71, 1, v71
    v_mad_u32_u24 v71, v90, s48, v71
    v_cmp_gt_u32 vcc, 135304, v79
    v_and_b32 v90, s50, v63
    s_and_b64 exec, exec, vcc
    s_cbranch_execz L_eft7
    buffer_load_dword v115, v90, s[16:19], 0 offen
L_eft7:
L_pr3:
    s_mov_b64 exec, -1
    s_waitcnt lgkmcnt(0)
    s_barrier
    ds_read_b32 v81, v99 offset:1020
    ds_read_b32 v82, v99 offset:1032
    s_mov_b64 exec, s[52:53]
    ds_read_b32 v72, v72
    s_mov_b64 exec, s[54:55]
    s_cbranch_execz L_st0
    ds_read_b32 v73, v73
L_st0:
    s_mov_b64 exec, s[56:57]
    ds_read_b32 v74, v74
    s_mov_b64 exec, s[58:59]
    s_cbranch_execz L_st1
    ds_read_b32 v75, v75
L_st1:
    s_mov_b64 exec, s[60:61]
    ds_read_b32 v76, v76
    s_mov_b64 exec, s[62:63]
    s_cbranch_execz L_st2
    ds_read_b32 v77, v77
L_st2:
    s_mov_b64 exec, s[64:65]
    ds_read_b32 v78, v78
    s_mov_b64 exec, s[66:67]
    s_cbranch_execz L_st3
    ds_read_b32 v79, v79
L_st3:
    s_mov_b64 exec, -1
    s_waitcnt lgkmcnt(0)
    v_readfirstlane_b32 s43, v81
    v_readfirstlane_b32 s51, v82
    s_cmp_le_u32 s43, 6144
    s_cbranch_scc1 L_fits
    s_mov_b32 s42, 3
    s_barrier
    s_branch L_round
L_fits:
    s_mov_b64 exec, s[52:53]
    v_add_u32 v80, v72, v64
    v_lshlrev_b32 v83, 1, v80
    ds_write_b32 v80, v34 offset:0
    ds_write_b32 v80, v35 offset:12416
    ds_write_b64 v83, v[32:33] offset:24832
    s_mov_b64 exec, s[54:55]
    s_cbranch_execz L_sc0
    v_add_u32 v80, v73, v65
    v_lshlrev_b32 v83, 1, v80
    ds_write_b32 v80, v38 offset:0
    ds_write_b32 v80, v39 offset:12416
    ds_write_b64 v83, v[36:37] offset:24832
L_sc0:
    s_mov_b64 exec, s[56:57]
    v_add_u32 v80, v74, v66
    v_lshlrev_b32 v83, 1, v80
    ds_write_b32 v80, v42 offset:0
    ds_write_b32 v80, v43 offset:12416
    ds_write_b64 v83, v[40:41] offset:24832
    s_mov_b64 exec, s[58:59]
    s_cbranch_execz L_sc1
    v_add_u32 v80, v75, v67
    v_lshlrev_b32 v83, 1, v80
    ds_write_b32 v80, v46 offset:0
    ds_write_b32 v80, v47 offset:12416
    ds_write_b64 v83, v[44:45] offset:24832
L_sc1:
    s_mov_b64 exec, s[60:61]
    v_add_u32 v80, v76, v68
    v_lshlrev_b32 v83, 1, v80
    ds_write_b32 v80, v50 offset:0
    ds_write_b32 v80, v51 offset:12416
    ds_write_b64 v83, v[48:49] offset:24832
    s_mov_b64 exec, s[62:63]
    s_cbranch_execz L_sc2
    v_add_u32 v80, v77, v69
    v_lshlrev_b32 v83, 1, v80
    ds_write_b32 v80, v54 offset:0
    ds_write_b32 v80, v55 offset:12416
    ds_write_b64 v83, v[52:53] offset:24832
L_sc2:
    s_mov_b64 exec, s[64:65]
    v_add_u32 v80, v78, v70
    v_lshlrev_b32 v83, 1, v80
    ds_write_b32 v80, v58 offset:0
    ds_write_b32 v80, v59 offset:12416
    ds_write_b64 v83, v[56:57] offset:24832
    s_mov_b64 exec, s[66:67]
    s_cbranch_execz L_sc3
    v_add_u32 v80, v79, v71
    v_lshlrev_b32 v83, 1, v80
    ds_write_b32 v80, v62 offset:0
    ds_write_b32 v80, v63 offset:12416
    ds_write_b64 v83, v[60:61] offset:24832
L_sc3:
    s_mov_b64 exec, -1
    v_mov_b32 v82, 0x81ffffe0
    s_add_u32 s43, s43, 63
    s_lshr_b32 s43, s43, 6
    ds_write_b32 v81, v82 offset:12416
    s_waitcnt lgkmcnt(0)
    s_barrier
    s_mul_i32 s48, s43, 5462
    s_lshr_b32 s48, s48, 16
    s_mul_i32 s48, s48, 12
    s_sub_u32 s48, s43, s48
    s_cmp_le_u32 s48, 3
    s_cselect_b32 s48, s48, 0
    s_min_u32 s68, s48, 3
    s_add_u32 s68, s68, 12
    s_add_u32 s69, s48, 14
    s_sub_u32 s69, s69, s39
    s_mul_i32 s69, s69, 21846
    s_lshr_b32 s69, s69, 16
    s_cmp_lt_u32 s39, 12
    s_cselect_b32 s69, 0x7fff, s69
    s_mov_b32 s70, s43
    s_min_u32 s48, s39, s68
    s_cmp_ge_u32 s48, s43
    s_cbranch_scc1 L_done
    s_cmp_ge_u32 s39, s68
    s_cbranch_scc1 L_loader
    s_setprio 3
    s_lshl_b32 s48, s39, 6
    s_lshl_b32 s49, s39, 7
    v_add_u32 v107, s48, v20
    v_add_u32 v73, s48, v19
    v_add_u32 v104, s49, v21
    ds_read_b32 v107, v107 offset:12416
    ds_read_b32 v73, v73 offset:0
    ds_read_b64 v[104:105], v104 offset:24832
    v_mov_b32 v112, 136256
    v_mov_b32 v113, 1
    v_mov_b32 v114, 0
    s_waitcnt lgkmcnt(0)
    v_and_or_b32 v96, v107, s50, v22
    v_cmp_gt_i32 s[44:45], 0, v107
    buffer_load_dwordx4 v[96:99], v96, s[16:19], 0 offen
    v_add_u32_dpp v74, v73, v1 row_newbcast:0 row_mask:0xf bank_mask:0xf
    buffer_load_dwordx4 v[56:59], v74, s[12:15], 0 offen
    v_add_u32_dpp v75, v73, v1 row_newbcast:1 row_mask:0xf bank_mask:0xf
    buffer_load_dwordx4 v[60:63], v75, s[12:15], 0 offen
    v_add_u32_dpp v74, v73, v1 row_newbcast:2 row_mask:0xf bank_mask:0xf
    buffer_load_dwordx4 v[64:67], v74, s[12:15], 0 offen
    v_add_u32_dpp v75, v73, v1 row_newbcast:3 row_mask:0xf bank_mask:0xf
    buffer_load_dwordx4 v[68:71], v75, s[12:15], 0 offen
    v_mfma_f32_4x4x4_16b_bf16 v[24:27], v[104:105], v[10:11], 0
    v_mfma_f32_4x4x4_16b_bf16 v[28:31], v[104:105], v[12:13], 0
    v_mfma_f32_4x4x4_16b_bf16 v[40:43], v[104:105], v[14:15], 0
    v_mfma_f32_4x4x4_16b_bf16 v[44:47], v[104:105], v[16:17], 0
    s_nop 4
    v_cvt_pk_bf16_f32 v92, v24, v28
    v_cvt_pk_bf16_f32 v93, v40, v44
    v_cvt_pk_bf16_f32 v94, v25, v29
    v_cvt_pk_bf16_f32 v95, v41, v45
    s_waitcnt vmcnt(4)
    v_mfma_f32_32x32x16_bf16 v[24:39], v[96:99], v[2:5], 0
    v_mfma_f32_32x32x16_bf16 v[40:55], v[96:99], v[6:9], 0
    s_nop 7
    s_branch L_enter
L_block:
    s_waitcnt vmcnt(3)
    v_mfma_f32_4x4x4_16b_bf16 v[76:79], v[92:93], v[56:57], 0 cbsz:3 abid:0
    v_exp_f32 v100, v26
    v_mfma_f32_4x4x4_16b_bf16 v[80:83], v[92:93], v[58:59], 0 cbsz:3 abid:0
    v_add_u32_dpp v74, v72, v1 row_newbcast:4 row_mask:0xf bank_mask:0xf
    buffer_load_dwordx4 v[56:59], v74, s[12:15], 0 offen
    v_exp_f32 v101, v27
    v_exp_f32 v102, v42
    v_exp_f32 v103, v43
    v_pk_mul_f32 v[84:85], v[76:77], v[24:25] op_sel:[0,0] op_sel_hi:[1,0]
    v_pk_mul_f32 v[86:87], v[78:79], v[24:25] op_sel:[0,0] op_sel_hi:[1,0]
    v_pk_mul_f32 v[88:89], v[80:81], v[40:41] op_sel:[0,0] op_sel_hi:[1,0]
    v_pk_mul_f32 v[90:91], v[82:83], v[40:41] op_sel:[0,0] op_sel_hi:[1,0]
    v_pk_add_f32 v[100:101], v[100:101], 1.0 op_sel_hi:[1,0]
    v_pk_add_f32 v[102:103], v[102:103], 1.0 op_sel_hi:[1,0]
    s_waitcnt vmcnt(3)
    v_mfma_f32_4x4x4_16b_bf16 v[76:79], v[92:93], v[60:61], 0 cbsz:3 abid:1
    v_rcp_f32 v100, v100
    v_mfma_f32_4x4x4_16b_bf16 v[80:83], v[92:93], v[62:63], 0 cbsz:3 abid:1
    v_add_u32_dpp v75, v72, v1 row_newbcast:5 row_mask:0xf bank_mask:0xf
    buffer_load_dwordx4 v[60:63], v75, s[12:15], 0 offen
    v_rcp_f32 v101, v101
    v_rcp_f32 v102, v102
    v_rcp_f32 v103, v103
    s_bitcmp1_b32 s47, 1
    s_cbranch_scc1 L_fl1
    v_pk_fma_f32 v[84:85], v[76:77], v[24:25], v[84:85] op_sel:[0,1,0] op_sel_hi:[1,1,1]
    v_pk_fma_f32 v[86:87], v[78:79], v[24:25], v[86:87] op_sel:[0,1,0] op_sel_hi:[1,1,1]
    v_pk_fma_f32 v[88:89], v[80:81], v[40:41], v[88:89] op_sel:[0,1,0] op_sel_hi:[1,1,1]
    v_pk_fma_f32 v[90:91], v[82:83], v[40:41], v[90:91] op_sel:[0,1,0] op_sel_hi:[1,1,1]
L_fr1:
    v_pk_mul_f32 v[26:27], v[26:27], v[100:101]
    v_pk_mul_f32 v[42:43], v[42:43], v[102:103]
    s_waitcnt vmcnt(3)
    v_mfma_f32_4x4x4_16b_bf16 v[76:79], v[92:93], v[64:65], 0 cbsz:3 abid:2
    v_exp_f32 v100, v28
    v_mfma_f32_4x4x4_16b_bf16 v[80:83], v[92:93], v[66:67], 0 cbsz:3 abid:2
    v_add_u32_dpp v74, v72, v1 row_newbcast:6 row_mask:0xf bank_mask:0xf
    buffer_load_dwordx4 v[64:67], v74, s[12:15], 0 offen
    v_exp_f32 v101, v29
    v_exp_f32 v102, v44
    v_exp_f32 v103, v45
    s_bitcmp1_b32 s47, 2
    s_cbranch_scc1 L_fl2
    v_pk_fma_f32 v[84:85], v[76:77], v[26:27], v[84:85] op_sel:[0,0,0] op_sel_hi:[1,0,1]
    v_pk_fma_f32 v[86:87], v[78:79], v[26:27], v[86:87] op_sel:[0,0,0] op_sel_hi:[1,0,1]
    v_pk_fma_f32 v[88:89], v[80:81], v[42:43], v[88:89] op_sel:[0,0,0] op_sel_hi:[1,0,1]
    v_pk_fma_f32 v[90:91], v[82:83], v[42:43], v[90:91] op_sel:[0,0,0] op_sel_hi:[1,0,1]
L_fr2:
    v_pk_add_f32 v[100:101], v[100:101], 1.0 op_sel_hi:[1,0]
    v_pk_add_f32 v[102:103], v[102:103], 1.0 op_sel_hi:[1,0]
    s_waitcnt vmcnt(3)
    v_mfma_f32_4x4x4_16b_bf16 v[76:79], v[92:93], v[68:69], 0 cbsz:3 abid:3
    v_rcp_f32 v100, v100
    v_mfma_f32_4x4x4_16b_bf16 v[80:83], v[92:93], v[70:71], 0 cbsz:3 abid:3
    v_add_u32_dpp v75, v72, v1 row_newbcast:7 row_mask:0xf bank_mask:0xf
    buffer_load_dwordx4 v[68:71], v75, s[12:15], 0 offen
    v_rcp_f32 v101, v101
    v_rcp_f32 v102, v102
    v_rcp_f32 v103, v103
    s_bitcmp1_b32 s47, 3
    s_cbranch_scc1 L_fl3
    v_pk_fma_f32 v[84:85], v[76:77], v[26:27], v[84:85] op_sel:[0,1,0] op_sel_hi:[1,1,1]
    v_pk_fma_f32 v[86:87], v[78:79], v[26:27], v[86:87] op_sel:[0,1,0] op_sel_hi:[1,1,1]
    v_pk_fma_f32 v[88:89], v[80:81], v[42:43], v[88:89] op_sel:[0,1,0] op_sel_hi:[1,1,1]
    v_pk_fma_f32 v[90:91], v[82:83], v[42:43], v[90:91] op_sel:[0,1,0] op_sel_hi:[1,1,1]
L_fr3:
    v_pk_mul_f32 v[28:29], v[28:29], v[100:101]
    v_pk_mul_f32 v[44:45], v[44:45], v[102:103]
    s_waitcnt vmcnt(3)
    v_mfma_f32_4x4x4_16b_bf16 v[76:79], v[92:93], v[56:57], 0 cbsz:3 abid:4
    v_exp_f32 v100, v30
    v_mfma_f32_4x4x4_16b_bf16 v[80:83], v[92:93], v[58:59], 0 cbsz:3 abid:4
    v_add_u32_dpp v74, v72, v1 row_newbcast:8 row_mask:0xf bank_mask:0xf
    buffer_load_dwordx4 v[56:59], v74, s[12:15], 0 offen
    v_exp_f32 v101, v31
    v_exp_f32 v102, v46
    v_exp_f32 v103, v47
    s_mov_b64 exec, 1
    ds_add_rtn_u32 v107, v112, v113
    s_mov_b64 exec, -1
    s_bitcmp1_b32 s47, 8
    s_cbranch_scc1 L_fl4
    v_pk_fma_f32 v[84:85], v[76:77], v[28:29], v[84:85] op_sel:[0,0,0] op_sel_hi:[1,0,1]
    v_pk_fma_f32 v[86:87], v[78:79], v[28:29], v[86:87] op_sel:[0,0,0] op_sel_hi:[1,0,1]
    v_pk_fma_f32 v[88:89], v[80:81], v[44:45], v[88:89] op_sel:[0,0,0] op_sel_hi:[1,0,1]
    v_pk_fma_f32 v[90:91], v[82:83], v[44:45], v[90:91] op_sel:[0,0,0] op_sel_hi:[1,0,1]
L_fr4:
    v_pk_add_f32 v[100:101], v[100:101], 1.0 op_sel_hi:[1,0]
    v_pk_add_f32 v[102:103], v[102:103], 1.0 op_sel_hi:[1,0]
    s_waitcnt vmcnt(3)
    v_mfma_f32_4x4x4_16b_bf16 v[76:79], v[92:93], v[60:61], 0 cbsz:3 abid:5
    v_rcp_f32 v100, v100
    v_mfma_f32_4x4x4_16b_bf16 v[80:83], v[92:93], v[62:63], 0 cbsz:3 abid:5
    v_add_u32_dpp v75, v72, v1 row_newbcast:9 row_mask:0xf bank_mask:0xf
    buffer_load_dwordx4 v[60:63], v75, s[12:15], 0 offen
    v_rcp_f32 v101, v101
    v_rcp_f32 v102, v102
    v_rcp_f32 v103, v103
    s_bitcmp1_b32 s47, 9
    s_cbranch_scc1 L_fl5
    v_pk_fma_f32 v[84:85], v[76:77], v[28:29], v[84:85] op_sel:[0,1,0] op_sel_hi:[1,1,1]
    v_pk_fma_f32 v[86:87], v[78:79], v[28:29], v[86:87] op_sel:[0,1,0] op_sel_hi:[1,1,1]
    v_pk_fma_f32 v[88:89], v[80:81], v[44:45], v[88:89] op_sel:[0,1,0] op_sel_hi:[1,1,1]
    v_pk_fma_f32 v[90:91], v[82:83], v[44:45], v[90:91] op_sel:[0,1,0] op_sel_hi:[1,1,1]
L_fr5:
    v_pk_mul_f32 v[30:31], v[30:31], v[100:101]
    v_pk_mul_f32 v[46:47], v[46:47], v[102:103]
    s_waitcnt vmcnt(3)
    v_mfma_f32_4x4x4_16b_bf16 v[76:79], v[92:93], v[64:65], 0 cbsz:3 abid:6
    v_exp_f32 v100, v32
    v_mfma_f32_4x4x4_16b_bf16 v[80:83], v[92:93], v[66:67], 0 cbsz:3 abid:6
    v_exp_f32 v101, v33
    v_exp_f32 v102, v48
    v_exp_f32 v103, v49
    s_waitcnt lgkmcnt(0)
    v_readfirstlane_b32 s46, v107
    s_add_u32 s46, s46, s68
    s_cmp_ge_u32 s46, s70
    s_cbranch_scc1 L_tail
    s_lshl_b32 s48, s46, 6
    s_lshl_b32 s49, s46, 7
    v_add_u32 v107, s48, v20
    v_add_u32 v73, s48, v19
    v_add_u32 v104, s49, v21
    ds_read_b32 v107, v107 offset:12416
    ds_read_b32 v73, v73 offset:0
    ds_read_b64 v[104:105], v104 offset:24832
    v_add_u32_dpp v74, v72, v1 row_newbcast:10 row_mask:0xf bank_mask:0xf
    buffer_load_dwordx4 v[64:67], v74, s[12:15], 0 offen
    s_bitcmp1_b32 s47, 10
    s_cbranch_scc1 L_fl6
    v_pk_fma_f32 v[84:85], v[76:77], v[30:31], v[84:85] op_sel:[0,0,0] op_sel_hi:[1,0,1]
    v_pk_fma_f32 v[86:87], v[78:79], v[30:31], v[86:87] op_sel:[0,0,0] op_sel_hi:[1,0,1]
    v_pk_fma_f32 v[88:89], v[80:81], v[46:47], v[88:89] op_sel:[0,0,0] op_sel_hi:[1,0,1]
    v_pk_fma_f32 v[90:91], v[82:83], v[46:47], v[90:91] op_sel:[0,0,0] op_sel_hi:[1,0,1]
L_fr6:
    v_pk_add_f32 v[100:101], v[100:101], 1.0 op_sel_hi:[1,0]
    v_pk_add_f32 v[102:103], v[102:103], 1.0 op_sel_hi:[1,0]
    s_waitcnt vmcnt(3)
    v_mfma_f32_4x4x4_16b_bf16 v[76:79], v[92:93], v[68:69], 0 cbsz:3 abid:7
    v_rcp_f32 v100, v100
    v_mfma_f32_4x4x4_16b_bf16 v[80:83], v[92:93], v[70:71], 0 cbsz:3 abid:7
    v_add_u32_dpp v75, v72, v1 row_newbcast:11 row_mask:0xf bank_mask:0xf
    buffer_load_dwordx4 v[68:71], v75, s[12:15], 0 offen
    v_rcp_f32 v101, v101
    v_rcp_f32 v102, v102
    v_rcp_f32 v103, v103
    s_bitcmp1_b32 s47, 11
    s_cbranch_scc1 L_fl7
    v_pk_fma_f32 v[84:85], v[76:77], v[30:31], v[84:85] op_sel:[0,1,0] op_sel_hi:[1,1,1]
    v_pk_fma_f32 v[86:87], v[78:79], v[30:31], v[86:87] op_sel:[0,1,0] op_sel_hi:[1,1,1]
    v_pk_fma_f32 v[88:89], v[80:81], v[46:47], v[88:89] op_sel:[0,1,0] op_sel_hi:[1,1,1]
    v_pk_fma_f32 v[90:91], v[82:83], v[46:47], v[90:91] op_sel:[0,1,0] op_sel_hi:[1,1,1]
L_fr7:
    v_pk_mul_f32 v[32:33], v[32:33], v[100:101]
    v_pk_mul_f32 v[48:49], v[48:49], v[102:103]
    s_waitcnt vmcnt(3)
    v_mfma_f32_4x4x4_16b_bf16 v[76:79], v[94:95], v[56:57], 0 cbsz:3 abid:0
    v_exp_f32 v100, v34
    v_mfma_f32_4x4x4_16b_bf16 v[80:83], v[94:95], v[58:59], 0 cbsz:3 abid:0
    v_add_u32_dpp v74, v72, v1 row_newbcast:12 row_mask:0xf bank_mask:0xf
    buffer_load_dwordx4 v[56:59], v74, s[12:15], 0 offen
    v_exp_f32 v101, v35
    v_exp_f32 v102, v50
    v_exp_f32 v103, v51
    s_waitcnt lgkmcnt(0)
    v_cmp_gt_i32 s[44:45], 0, v107
    s_bitcmp1_b32 s47, 16
    s_cbranch_scc1 L_fl8
    v_pk_fma_f32 v[84:85], v[76:77], v[32:33], v[84:85] op_sel:[0,0,0] op_sel_hi:[1,0,1]
    v_pk_fma_f32 v[86:87], v[78:79], v[32:33], v[86:87] op_sel:[0,0,0] op_sel_hi:[1,0,1]
    v_pk_fma_f32 v[88:89], v[80:81], v[48:49], v[88:89] op_sel:[0,0,0] op_sel_hi:[1,0,1]
    v_pk_fma_f32 v[90:91], v[82:83], v[48:49], v[90:91] op_sel:[0,0,0] op_sel_hi:[1,0,1]
L_fr8:
    v_pk_add_f32 v[100:101], v[100:101], 1.0 op_sel_hi:[1,0]
    v_pk_add_f32 v[102:103], v[102:103], 1.0 op_sel_hi:[1,0]
    s_waitcnt vmcnt(3)
    v_mfma_f32_4x4x4_16b_bf16 v[76:79], v[94:95], v[60:61], 0 cbsz:3 abid:1
    v_rcp_f32 v100, v100
    v_mfma_f32_4x4x4_16b_bf16 v[80:83], v[94:95], v[62:63], 0 cbsz:3 abid:1
    v_add_u32_dpp v75, v72, v1 row_newbcast:13 row_mask:0xf bank_mask:0xf
    buffer_load_dwordx4 v[60:63], v75, s[12:15], 0 offen
    v_rcp_f32 v101, v101
    v_mfma_f32_4x4x4_16b_bf16 v[24:27], v[104:105], v[10:11], 0
    v_rcp_f32 v102, v102
    v_mfma_f32_4x4x4_16b_bf16 v[28:31], v[104:105], v[12:13], 0
    v_rcp_f32 v103, v103
    s_bitcmp1_b32 s47, 17
    s_cbranch_scc1 L_fl9
    v_pk_fma_f32 v[84:85], v[76:77], v[32:33], v[84:85] op_sel:[0,1,0] op_sel_hi:[1,1,1]
    v_pk_fma_f32 v[86:87], v[78:79], v[32:33], v[86:87] op_sel:[0,1,0] op_sel_hi:[1,1,1]
    v_pk_fma_f32 v[88:89], v[80:81], v[48:49], v[88:89] op_sel:[0,1,0] op_sel_hi:[1,1,1]
    v_pk_fma_f32 v[90:91], v[82:83], v[48:49], v[90:91] op_sel:[0,1,0] op_sel_hi:[1,1,1]
L_fr9:
    v_pk_mul_f32 v[34:35], v[34:35], v[100:101]
    v_pk_mul_f32 v[50:51], v[50:51], v[102:103]
    s_waitcnt vmcnt(3)
    v_mfma_f32_4x4x4_16b_bf16 v[76:79], v[94:95], v[64:65], 0 cbsz:3 abid:2
    v_exp_f32 v100, v36
    v_mfma_f32_4x4x4_16b_bf16 v[80:83], v[94:95], v[66:67], 0 cbsz:3 abid:2
    v_add_u32_dpp v74, v72, v1 row_newbcast:14 row_mask:0xf bank_mask:0xf
    buffer_load_dwordx4 v[64:67], v74, s[12:15], 0 offen
    v_exp_f32 v101, v37
    v_mfma_f32_4x4x4_16b_bf16 v[40:43], v[104:105], v[14:15], 0
    v_exp_f32 v102, v52
    v_mfma_f32_4x4x4_16b_bf16 v[44:47], v[104:105], v[16:17], 0
    v_exp_f32 v103, v53
    s_bitcmp1_b32 s47, 18
    s_cbranch_scc1 L_fl10
    v_pk_fma_f32 v[84:85], v[76:77], v[34:35], v[84:85] op_sel:[0,0,0] op_sel_hi:[1,0,1]
    v_pk_fma_f32 v[86:87], v[78:79], v[34:35], v[86:87] op_sel:[0,0,0] op_sel_hi:[1,0,1]
    v_pk_fma_f32 v[88:89], v[80:81], v[50:51], v[88:89] op_sel:[0,0,0] op_sel_hi:[1,0,1]
    v_pk_fma_f32 v[90:91], v[82:83], v[50:51], v[90:91] op_sel:[0,0,0] op_sel_hi:[1,0,1]
L_fr10:
    v_pk_add_f32 v[100:101], v[100:101], 1.0 op_sel_hi:[1,0]
    v_pk_add_f32 v[102:103], v[102:103], 1.0 op_sel_hi:[1,0]
    s_waitcnt vmcnt(3)
    v_mfma_f32_4x4x4_16b_bf16 v[76:79], v[94:95], v[68:69], 0 cbsz:3 abid:3
    v_rcp_f32 v100, v100
    v_mfma_f32_4x4x4_16b_bf16 v[80:83], v[94:95], v[70:71], 0 cbsz:3 abid:3
    v_add_u32_dpp v75, v72, v1 row_newbcast:15 row_mask:0xf bank_mask:0xf
    buffer_load_dwordx4 v[68:71], v75, s[12:15], 0 offen
    v_rcp_f32 v101, v101
    v_rcp_f32 v102, v102
    v_rcp_f32 v103, v103
    s_bitcmp1_b32 s47, 19
    s_cbranch_scc1 L_fl11
    v_pk_fma_f32 v[84:85], v[76:77], v[34:35], v[84:85] op_sel:[0,1,0] op_sel_hi:[1,1,1]
    v_pk_fma_f32 v[86:87], v[78:79], v[34:35], v[86:87] op_sel:[0,1,0] op_sel_hi:[1,1,1]
    v_pk_fma_f32 v[88:89], v[80:81], v[50:51], v[88:89] op_sel:[0,1,0] op_sel_hi:[1,1,1]
    v_pk_fma_f32 v[90:91], v[82:83], v[50:51], v[90:91] op_sel:[0,1,0] op_sel_hi:[1,1,1]
L_fr11:
    v_pk_mul_f32 v[36:37], v[36:37], v[100:101]
    v_pk_mul_f32 v[52:53], v[52:53], v[102:103]
    s_waitcnt vmcnt(3)
    v_mfma_f32_4x4x4_16b_bf16 v[76:79], v[94:95], v[56:57], 0 cbsz:3 abid:4
    v_exp_f32 v100, v38
    v_mfma_f32_4x4x4_16b_bf16 v[80:83], v[94:95], v[58:59], 0 cbsz:3 abid:4
    v_add_u32_dpp v74, v73, v1 row_newbcast:0 row_mask:0xf bank_mask:0xf
    buffer_load_dwordx4 v[56:59], v74, s[12:15], 0 offen
    v_exp_f32 v101, v39
    v_exp_f32 v102, v54
    v_exp_f32 v103, v55
    v_cvt_pk_bf16_f32 v92, v24, v28
    v_cvt_pk_bf16_f32 v93, v40, v44
    s_bitcmp1_b32 s47, 24
    s_cbranch_scc1 L_fl12
    v_pk_fma_f32 v[84:85], v[76:77], v[36:37], v[84:85] op_sel:[0,0,0] op_sel_hi:[1,0,1]
    v_pk_fma_f32 v[86:87], v[78:79], v[36:37], v[86:87] op_sel:[0,0,0] op_sel_hi:[1,0,1]
    v_pk_fma_f32 v[88:89], v[80:81], v[52:53], v[88:89] op_sel:[0,0,0] op_sel_hi:[1,0,1]
    v_pk_fma_f32 v[90:91], v[82:83], v[52:53], v[90:91] op_sel:[0,0,0] op_sel_hi:[1,0,1]
L_fr12:
    v_pk_add_f32 v[100:101], v[100:101], 1.0 op_sel_hi:[1,0]
    v_pk_add_f32 v[102:103], v[102:103], 1.0 op_sel_hi:[1,0]
    s_waitcnt vmcnt(3)
    v_mfma_f32_4x4x4_16b_bf16 v[76:79], v[94:95], v[60:61], 0 cbsz:3 abid:5
    v_rcp_f32 v100, v100
    v_mfma_f32_4x4x4_16b_bf16 v[80:83], v[94:95], v[62:63], 0 cbsz:3 abid:5
    v_add_u32_dpp v75, v73, v1 row_newbcast:1 row_mask:0xf bank_mask:0xf
    buffer_load_dwordx4 v[60:63], v75, s[12:15], 0 offen
    v_rcp_f32 v101, v101
    v_rcp_f32 v102, v102
    v_rcp_f32 v103, v103
    s_and_b32 s48, s46, 15
    s_lshl_b32 s49, s48, 10
    s_lshl_b32 s48, s48, 2
    s_add_u32 s48, s48, 136320
    v_add_u32 v111, s49, v23
    v_mov_b32 v109, s48
    ds_read_b32 v110, v109
    ds_read_b128 v[96:99], v111
    s_bitcmp1_b32 s47, 25
    s_cbranch_scc1 L_fl13
    v_pk_fma_f32 v[84:85], v[76:77], v[36:37], v[84:85] op_sel:[0,1,0] op_sel_hi:[1,1,1]
    v_pk_fma_f32 v[86:87], v[78:79], v[36:37], v[86:87] op_sel:[0,1,0] op_sel_hi:[1,1,1]
    v_pk_fma_f32 v[88:89], v[80:81], v[52:53], v[88:89] op_sel:[0,1,0] op_sel_hi:[1,1,1]
    v_pk_fma_f32 v[90:91], v[82:83], v[52:53], v[90:91] op_sel:[0,1,0] op_sel_hi:[1,1,1]
L_fr13:
    v_pk_mul_f32 v[38:39], v[38:39], v[100:101]
    v_pk_mul_f32 v[54:55], v[54:55], v[102:103]
    s_waitcnt vmcnt(3)
    v_mfma_f32_4x4x4_16b_bf16 v[76:79], v[94:95], v[64:65], 0 cbsz:3 abid:6
    v_mfma_f32_4x4x4_16b_bf16 v[80:83], v[94:95], v[66:67], 0 cbsz:3 abid:6
    v_add_u32_dpp v74, v73, v1 row_newbcast:2 row_mask:0xf bank_mask:0xf
    buffer_load_dwordx4 v[64:67], v74, s[12:15], 0 offen
    s_nop 0
    s_bitcmp1_b32 s47, 26
    s_cbranch_scc1 L_fl14
    v_pk_fma_f32 v[84:85], v[76:77], v[38:39], v[84:85] op_sel:[0,0,0] op_sel_hi:[1,0,1]
    v_pk_fma_f32 v[86:87], v[78:79], v[38:39], v[86:87] op_sel:[0,0,0] op_sel_hi:[1,0,1]
    v_pk_fma_f32 v[88:89], v[80:81], v[54:55], v[88:89] op_sel:[0,0,0] op_sel_hi:[1,0,1]
    v_pk_fma_f32 v[90:91], v[82:83], v[54:55], v[90:91] op_sel:[0,0,0] op_sel_hi:[1,0,1]
L_fr14:
    s_waitcnt vmcnt(3)
    v_mfma_f32_4x4x4_16b_bf16 v[76:79], v[94:95], v[68:69], 0 cbsz:3 abid:7
    v_mfma_f32_4x4x4_16b_bf16 v[80:83], v[94:95], v[70:71], 0 cbsz:3 abid:7
    v_add_u32_dpp v75, v73, v1 row_newbcast:3 row_mask:0xf bank_mask:0xf
    buffer_load_dwordx4 v[68:71], v75, s[12:15], 0 offen
    v_cvt_pk_bf16_f32 v94, v25, v29
    v_cvt_pk_bf16_f32 v95, v41, v45
    s_waitcnt lgkmcnt(0)
    v_readfirstlane_b32 s48, v110
    s_cmp_lg_u32 s48, s46
    s_cbranch_scc1 L_ring_wait
L_ring_ok:
    ds_write_b32 v109, v114
    s_bitcmp1_b32 s47, 27
    s_cbranch_scc1 L_fl15
    v_pk_fma_f32 v[84:85], v[76:77], v[38:39], v[84:85] op_sel:[0,1,0] op_sel_hi:[1,1,1]
    v_pk_fma_f32 v[86:87], v[78:79], v[38:39], v[86:87] op_sel:[0,1,0] op_sel_hi:[1,1,1]
    v_pk_fma_f32 v[88:89], v[80:81], v[54:55], v[88:89] op_sel:[0,1,0] op_sel_hi:[1,1,1]
    v_pk_fma_f32 v[90:91], v[82:83], v[54:55], v[90:91] op_sel:[0,1,0] op_sel_hi:[1,1,1]
L_fr15:
    v_mfma_f32_32x32x16_bf16 v[24:39], v[96:99], v[2:5], 0
    v_mfma_f32_32x32x16_bf16 v[40:55], v[96:99], v[6:9], 0
    v_readlane_b32 s48, v106, 27
    s_nop 0
    v_permlane32_swap_b32 v84, v88
    s_bfe_u32 s48, s48, 0x60019
    s_mul_i32 s48, s48, 2112
    v_permlane32_swap_b32 v85, v89
    v_permlane32_swap_b32 v86, v90
    v_permlane32_swap_b32 v87, v91
    v_add_u32 v108, s48, v18
    v_add_f32 v84, v84, v88
    v_add_f32 v85, v85, v89
    v_cvt_f64_f32 v[88:89], v84
    v_cvt_f64_f32 v[84:85], v85
    ds_add_f64 v108, v[88:89] offset:0
    ds_add_f64 v108, v[84:85] offset:528
    v_add_f32 v86, v86, v90
    v_add_f32 v87, v87, v91
    v_cvt_f64_f32 v[90:91], v86
    v_cvt_f64_f32 v[86:87], v87
    ds_add_f64 v108, v[90:91] offset:1056
    ds_add_f64 v108, v[86:87] offset:1584
    s_mul_i32 s48, s46, 2
    s_sub_u32 s48, s48, s43
    s_cbranch_scc1 L_enter
    s_setprio 2
L_enter:
    v_mov_b32 v106, v107
    v_mov_b32 v72, v73
    s_mov_b32 s47, s44
    s_sub_u32 s69, s69, 1
    s_cmp_lg_u32 s69, 0
    s_cbranch_scc1 L_more
    v_mov_b32 v113, 0
    s_mov_b32 s70, 0
L_more:
    v_exp_f32 v100, v24
    v_exp_f32 v101, v25
    v_exp_f32 v102, v40
    v_exp_f32 v103, v41
    s_nop 0
    v_pk_add_f32 v[100:101], v[100:101], 1.0 op_sel_hi:[1,0]
    v_pk_add_f32 v[102:103], v[102:103], 1.0 op_sel_hi:[1,0]
    v_rcp_f32 v100, v100
    v_rcp_f32 v101, v101
    v_rcp_f32 v102, v102
    v_rcp_f32 v103, v103
    s_nop 0
    v_pk_mul_f32 v[24:25], v[24:25], v[100:101]
    v_pk_mul_f32 v[40:41], v[40:41], v[102:103]
    s_branch L_block
L_ring_wait:
    s_add_u32 s6, s6, 1
    s_cmp_ge_u32 s6, 2097152
    s_cbranch_scc1 L_end
    s_sleep 1
    ds_read_b32 v110, v109
    ds_read_b128 v[96:99], v111
    s_waitcnt lgkmcnt(0)
    v_readfirstlane_b32 s48, v110
    s_cmp_lg_u32 s48, s46
    s_cbranch_scc1 L_ring_wait
    s_branch L_ring_ok
L_loader:
    s_cmp_lt_u32 s39, 15
    s_cbranch_scc1 L_done
    s_setprio 3
    s_lshr_b32 s48, s2, 3
    s_mul_i32 s48, s48, 5
    s_lshr_b32 s48, s48, 5
    s_mul_i32 s46, s39, 5
    s_sub_u32 s46, s46, s48
    s_sub_u32 s46, s46, 75
    s_add_u32 s46, s46, s68
    s_cmp_ge_u32 s46, s43
    s_cbranch_scc1 L_done
    s_sub_u32 s47, s43, s68
    s_mov_b32 s45, 0
    v_and_b32 v108, 63, v0
    v_bfe_u32 v56, v108, 3, 1
    v_mul_u32_u24 v56, 1552, v56
    v_bfe_u32 v57, v108, 4, 2
    v_lshl_add_u32 v56, v57, 2, v56
    v_bfe_u32 v57, v108, 1, 2
    v_add_lshl_u32 v56, v56, v57, 2
    v_and_b32 v57, 1, v108
    v_lshlrev_b32 v57, 4, v57
    v_mov_b32 v104, 136256
L_ld_batch:
    s_lshl_b32 s48, s46, 6
    v_add_u32 v76, s48, v56
    ds_read_b32 v24, v76 offset:12416
    ds_read_b32 v25, v76 offset:12480
    ds_read_b32 v26, v76 offset:12544
    ds_read_b32 v27, v76 offset:12608
    ds_read_b32 v28, v76 offset:12672
    v_add_u32 v110, s46, v108
    v_and_b32 v109, 15, v110
    v_lshlrev_b32 v109, 2, v109
    v_add_u32 v109, 136320, v109
    v_subrev_u32 v111, s68, v110
    v_cmp_gt_u32 vcc, s47, v111
    s_and_b32 s44, vcc_lo, 31
    s_waitcnt lgkmcnt(0)
    v_and_or_b32 v24, v24, s50, v57
    v_and_or_b32 v25, v25, s50, v57
    v_and_or_b32 v26, v26, s50, v57
    v_and_or_b32 v27, v27, s50, v57
    v_and_or_b32 v28, v28, s50, v57
L_ld_wait:
    ds_read_b32 v111, v109
    ds_read_b32 v77, v104
    s_waitcnt lgkmcnt(0)
    v_cmp_ne_u32 vcc, 0, v111
    v_readfirstlane_b32 s49, v77
    s_add_u32 s49, s49, s68
    s_sub_u32 s49, s49, 2
    s_cmp_lt_u32 s49, s46
    s_cselect_b32 s49, -1, 0
    s_or_b32 s49, s49, vcc_lo
    s_and_b32 s48, s49, s44
    s_cbranch_scc0 L_ld_go
    s_add_u32 s6, s6, 1
    s_cmp_ge_u32 s6, 2097152
    s_cbranch_scc1 L_end
    s_sleep 2
    s_branch L_ld_wait
L_ld_go:
    s_bitcmp0_b32 s44, 0
    s_cbranch_scc1 L_ld_skip0
    s_add_u32 s48, s46, 0
    s_and_b32 s48, s48, 15
    s_lshl_b32 s48, s48, 10
    s_add_u32 m0, s48, 145600
    s_nop 0
    buffer_load_dwordx4 v24, s[16:19], 0 offen lds
L_ld_skip0:
    s_bitcmp0_b32 s44, 1
    s_cbranch_scc1 L_ld_skip1
    s_add_u32 s48, s46, 1
    s_and_b32 s48, s48, 15
    s_lshl_b32 s48, s48, 10
    s_add_u32 m0, s48, 145600
    s_nop 0
    buffer_load_dwordx4 v25, s[16:19], 0 offen lds
L_ld_skip1:
    s_bitcmp0_b32 s44, 2
    s_cbranch_scc1 L_ld_skip2
    s_add_u32 s48, s46, 2
    s_and_b32 s48, s48, 15
    s_lshl_b32 s48, s48, 10
    s_add_u32 m0, s48, 145600
    s_nop 0
    buffer_load_dwordx4 v26, s[16:19], 0 offen lds
L_ld_skip2:
    s_bitcmp0_b32 s44, 3
    s_cbranch_scc1 L_ld_skip3
    s_add_u32 s48, s46, 3
    s_and_b32 s48, s48, 15
    s_lshl_b32 s48, s48, 10
    s_add_u32 m0, s48, 145600
    s_nop 0
    buffer_load_dwordx4 v27, s[16:19], 0 offen lds
L_ld_skip3:
    s_bitcmp0_b32 s44, 4
    s_cbranch_scc1 L_ld_skip4
    s_add_u32 s48, s46, 4
    s_and_b32 s48, s48, 15
    s_lshl_b32 s48, s48, 10
    s_add_u32 m0, s48, 145600
    s_nop 0
    buffer_load_dwordx4 v28, s[16:19], 0 offen lds
L_ld_skip4:
    s_waitcnt vmcnt(0)
    s_mov_b64 exec, s[44:45]
    ds_write_b32 v109, v110
    s_mov_b64 exec, -1
    s_add_u32 s46, s46, 5
    s_cmp_lt_u32 s46, s43
    s_cbranch_scc1 L_ld_batch
    s_branch L_done
L_fl1:
    v_readlane_b32 s48, v106, 0
    s_nop 0
    v_permlane32_swap_b32 v84, v88
    s_bfe_u32 s48, s48, 0x60019
    s_mul_i32 s48, s48, 2112
    v_permlane32_swap_b32 v85, v89
    v_permlane32_swap_b32 v86, v90
    v_permlane32_swap_b32 v87, v91
    v_add_u32 v108, s48, v18
    v_pk_add_f32 v[84:85], v[84:85], v[88:89]
    v_cvt_f64_f32 v[88:89], v84
    v_cvt_f64_f32 v[84:85], v85
    ds_add_f64 v108, v[88:89] offset:0
    ds_add_f64 v108, v[84:85] offset:528
    v_pk_add_f32 v[86:87], v[86:87], v[90:91]
    v_cvt_f64_f32 v[90:91], v86
    v_cvt_f64_f32 v[86:87], v87
    ds_add_f64 v108, v[90:91] offset:1056
    ds_add_f64 v108, v[86:87] offset:1584
    v_pk_mul_f32 v[84:85], v[76:77], v[24:25] op_sel:[0,1] op_sel_hi:[1,1]
    v_pk_mul_f32 v[86:87], v[78:79], v[24:25] op_sel:[0,1] op_sel_hi:[1,1]
    v_pk_mul_f32 v[88:89], v[80:81], v[40:41] op_sel:[0,1] op_sel_hi:[1,1]
    v_pk_mul_f32 v[90:91], v[82:83], v[40:41] op_sel:[0,1] op_sel_hi:[1,1]
    s_branch L_fr1
L_fl2:
    v_readlane_b32 s48, v106, 1
    s_nop 0
    v_permlane32_swap_b32 v84, v88
    s_bfe_u32 s48, s48, 0x60019
    s_mul_i32 s48, s48, 2112
    v_permlane32_swap_b32 v85, v89
    v_permlane32_swap_b32 v86, v90
    v_permlane32_swap_b32 v87, v91
    v_add_u32 v108, s48, v18
    v_pk_add_f32 v[84:85], v[84:85], v[88:89]
    v_cvt_f64_f32 v[88:89], v84
    v_cvt_f64_f32 v[84:85], v85
    ds_add_f64 v108, v[88:89] offset:0
    ds_add_f64 v108, v[84:85] offset:528
    v_pk_add_f32 v[86:87], v[86:87], v[90:91]
    v_cvt_f64_f32 v[90:91], v86
    v_cvt_f64_f32 v[86:87], v87
    ds_add_f64 v108, v[90:91] offset:1056
    ds_add_f64 v108, v[86:87] offset:1584
    v_pk_mul_f32 v[84:85], v[76:77], v[26:27] op_sel:[0,0] op_sel_hi:[1,0]
    v_pk_mul_f32 v[86:87], v[78:79], v[26:27] op_sel:[0,0] op_sel_hi:[1,0]
    v_pk_mul_f32 v[88:89], v[80:81], v[42:43] op_sel:[0,0] op_sel_hi:[1,0]
    v_pk_mul_f32 v[90:91], v[82:83], v[42:43] op_sel:[0,0] op_sel_hi:[1,0]
    s_branch L_fr2
L_fl3:
    v_readlane_b32 s48, v106, 2
    s_nop 0
    v_permlane32_swap_b32 v84, v88
    s_bfe_u32 s48, s48, 0x60019
    s_mul_i32 s48, s48, 2112
    v_permlane32_swap_b32 v85, v89
    v_permlane32_swap_b32 v86, v90
    v_permlane32_swap_b32 v87, v91
    v_add_u32 v108, s48, v18
    v_pk_add_f32 v[84:85], v[84:85], v[88:89]
    v_cvt_f64_f32 v[88:89], v84
    v_cvt_f64_f32 v[84:85], v85
    ds_add_f64 v108, v[88:89] offset:0
    ds_add_f64 v108, v[84:85] offset:528
    v_pk_add_f32 v[86:87], v[86:87], v[90:91]
    v_cvt_f64_f32 v[90:91], v86
    v_cvt_f64_f32 v[86:87], v87
    ds_add_f64 v108, v[90:91] offset:1056
    ds_add_f64 v108, v[86:87] offset:1584
    v_pk_mul_f32 v[84:85], v[76:77], v[26:27] op_sel:[0,1] op_sel_hi:[1,1]
    v_pk_mul_f32 v[86:87], v[78:79], v[26:27] op_sel:[0,1] op_sel_hi:[1,1]
    v_pk_mul_f32 v[88:89], v[80:81], v[42:43] op_sel:[0,1] op_sel_hi:[1,1]
    v_pk_mul_f32 v[90:91], v[82:83], v[42:43] op_sel:[0,1] op_sel_hi:[1,1]
    s_branch L_fr3
L_fl4:
    v_readlane_b32 s48, v106, 3
    s_nop 0
    v_permlane32_swap_b32 v84, v88
    s_bfe_u32 s48, s48, 0x60019
    s_mul_i32 s48, s48, 2112
    v_permlane32_swap_b32 v85, v89
    v_permlane32_swap_b32 v86, v90
    v_permlane32_swap_b32 v87, v91
    v_add_u32 v108, s48, v18
    v_pk_add_f32 v[84:85], v[84:85], v[88:89]
    v_cvt_f64_f32 v[88:89], v84
    v_cvt_f64_f32 v[84:85], v85
    ds_add_f64 v108, v[88:89] offset:0
    ds_add_f64 v108, v[84:85] offset:528
    v_pk_add_f32 v[86:87], v[86:87], v[90:91]
    v_cvt_f64_f32 v[90:91], v86
    v_cvt_f64_f32 v[86:87], v87
    ds_add_f64 v108, v[90:91] offset:1056
    ds_add_f64 v108, v[86:87] offset:1584
    v_pk_mul_f32 v[84:85], v[76:77], v[28:29] op_sel:[0,0] op_sel_hi:[1,0]
    v_pk_mul_f32 v[86:87], v[78:79], v[28:29] op_sel:[0,0] op_sel_hi:[1,0]
    v_pk_mul_f32 v[88:89], v[80:81], v[44:45] op_sel:[0,0] op_sel_hi:[1,0]
    v_pk_mul_f32 v[90:91], v[82:83], v[44:45] op_sel:[0,0] op_sel_hi:[1,0]
    s_branch L_fr4
L_fl5:
    v_readlane_b32 s48, v106, 8
    s_nop 0
    v_permlane32_swap_b32 v84, v88
    s_bfe_u32 s48, s48, 0x60019
    s_mul_i32 s48, s48, 2112
    v_permlane32_swap_b32 v85, v89
    v_permlane32_swap_b32 v86, v90
    v_permlane32_swap_b32 v87, v91
    v_add_u32 v108, s48, v18
    v_pk_add_f32 v[84:85], v[84:85], v[88:89]
    v_cvt_f64_f32 v[88:89], v84
    v_cvt_f64_f32 v[84:85], v85
    ds_add_f64 v108, v[88:89] offset:0
    ds_add_f64 v108, v[84:85] offset:528
    v_pk_add_f32 v[86:87], v[86:87], v[90:91]
    v_cvt_f64_f32 v[90:91], v86
    v_cvt_f64_f32 v[86:87], v87
    ds_add_f64 v108, v[90:91] offset:1056
    ds_add_f64 v108, v[86:87] offset:1584
    v_pk_mul_f32 v[84:85], v[76:77], v[28:29] op_sel:[0,1] op_sel_hi:[1,1]
    v_pk_mul_f32 v[86:87], v[78:79], v[28:29] op_sel:[0,1] op_sel_hi:[1,1]
    v_pk_mul_f32 v[88:89], v[80:81], v[44:45] op_sel:[0,1] op_sel_hi:[1,1]
    v_pk_mul_f32 v[90:91], v[82:83], v[44:45] op_sel:[0,1] op_sel_hi:[1,1]
    s_branch L_fr5
L_fl6:
    v_readlane_b32 s48, v106, 9
    s_nop 0
    v_permlane32_swap_b32 v84, v88
    s_bfe_u32 s48, s48, 0x60019
    s_mul_i32 s48, s48, 2112
    v_permlane32_swap_b32 v85, v89
    v_permlane32_swap_b32 v86, v90
    v_permlane32_swap_b32 v87, v91
    v_add_u32 v108, s48, v18
    v_pk_add_f32 v[84:85], v[84:85], v[88:89]
    v_cvt_f64_f32 v[88:89], v84
    v_cvt_f64_f32 v[84:85], v85
    ds_add_f64 v108, v[88:89] offset:0
    ds_add_f64 v108, v[84:85] offset:528
    v_pk_add_f32 v[86:87], v[86:87], v[90:91]
    v_cvt_f64_f32 v[90:91], v86
    v_cvt_f64_f32 v[86:87], v87
    ds_add_f64 v108, v[90:91] offset:1056
    ds_add_f64 v108, v[86:87] offset:1584
    v_pk_mul_f32 v[84:85], v[76:77], v[30:31] op_sel:[0,0] op_sel_hi:[1,0]
    v_pk_mul_f32 v[86:87], v[78:79], v[30:31] op_sel:[0,0] op_sel_hi:[1,0]
    v_pk_mul_f32 v[88:89], v[80:81], v[46:47] op_sel:[0,0] op_sel_hi:[1,0]
    v_pk_mul_f32 v[90:91], v[82:83], v[46:47] op_sel:[0,0] op_sel_hi:[1,0]
    s_branch L_fr6
L_fl7:
    v_readlane_b32 s48, v106, 10
    s_nop 0
    v_permlane32_swap_b32 v84, v88
    s_bfe_u32 s48, s48, 0x60019
    s_mul_i32 s48, s48, 2112
    v_permlane32_swap_b32 v85, v89
    v_permlane32_swap_b32 v86, v90
    v_permlane32_swap_b32 v87, v91
    v_add_u32 v108, s48, v18
    v_pk_add_f32 v[84:85], v[84:85], v[88:89]
    v_cvt_f64_f32 v[88:89], v84
    v_cvt_f64_f32 v[84:85], v85
    ds_add_f64 v108, v[88:89] offset:0
    ds_add_f64 v108, v[84:85] offset:528
    v_pk_add_f32 v[86:87], v[86:87], v[90:91]
    v_cvt_f64_f32 v[90:91], v86
    v_cvt_f64_f32 v[86:87], v87
    ds_add_f64 v108, v[90:91] offset:1056
    ds_add_f64 v108, v[86:87] offset:1584
    v_pk_mul_f32 v[84:85], v[76:77], v[30:31] op_sel:[0,1] op_sel_hi:[1,1]
    v_pk_mul_f32 v[86:87], v[78:79], v[30:31] op_sel:[0,1] op_sel_hi:[1,1]
    v_pk_mul_f32 v[88:89], v[80:81], v[46:47] op_sel:[0,1] op_sel_hi:[1,1]
    v_pk_mul_f32 v[90:91], v[82:83], v[46:47] op_sel:[0,1] op_sel_hi:[1,1]
    s_branch L_fr7
L_fl8:
    v_readlane_b32 s48, v106, 11
    s_nop 0
    v_permlane32_swap_b32 v84, v88
    s_bfe_u32 s48, s48, 0x60019
    s_mul_i32 s48, s48, 2112
    v_permlane32_swap_b32 v85, v89
    v_permlane32_swap_b32 v86, v90
    v_permlane32_swap_b32 v87, v91
    v_add_u32 v108, s48, v18
    v_pk_add_f32 v[84:85], v[84:85], v[88:89]
    v_cvt_f64_f32 v[88:89], v84
    v_cvt_f64_f32 v[84:85], v85
    ds_add_f64 v108, v[88:89] offset:0
    ds_add_f64 v108, v[84:85] offset:528
    v_pk_add_f32 v[86:87], v[86:87], v[90:91]
    v_cvt_f64_f32 v[90:91], v86
    v_cvt_f64_f32 v[86:87], v87
    ds_add_f64 v108, v[90:91] offset:1056
    ds_add_f64 v108, v[86:87] offset:1584
    v_pk_mul_f32 v[84:85], v[76:77], v[32:33] op_sel:[0,0] op_sel_hi:[1,0]
    v_pk_mul_f32 v[86:87], v[78:79], v[32:33] op_sel:[0,0] op_sel_hi:[1,0]
    v_pk_mul_f32 v[88:89], v[80:81], v[48:49] op_sel:[0,0] op_sel_hi:[1,0]
    v_pk_mul_f32 v[90:91], v[82:83], v[48:49] op_sel:[0,0] op_sel_hi:[1,0]
    s_branch L_fr8
L_fl9:
    v_readlane_b32 s48, v106, 16
    s_nop 0
    v_permlane32_swap_b32 v84, v88
    s_bfe_u32 s48, s48, 0x60019
    s_mul_i32 s48, s48, 2112
    v_permlane32_swap_b32 v85, v89
    v_permlane32_swap_b32 v86, v90
    v_permlane32_swap_b32 v87, v91
    v_add_u32 v108, s48, v18
    v_pk_add_f32 v[84:85], v[84:85], v[88:89]
    v_cvt_f64_f32 v[88:89], v84
    v_cvt_f64_f32 v[84:85], v85
    ds_add_f64 v108, v[88:89] offset:0
    ds_add_f64 v108, v[84:85] offset:528
    v_pk_add_f32 v[86:87], v[86:87], v[90:91]
    v_cvt_f64_f32 v[90:91], v86
    v_cvt_f64_f32 v[86:87], v87
    ds_add_f64 v108, v[90:91] offset:1056
    ds_add_f64 v108, v[86:87] offset:1584
    v_pk_mul_f32 v[84:85], v[76:77], v[32:33] op_sel:[0,1] op_sel_hi:[1,1]
    v_pk_mul_f32 v[86:87], v[78:79], v[32:33] op_sel:[0,1] op_sel_hi:[1,1]
    v_pk_mul_f32 v[88:89], v[80:81], v[48:49] op_sel:[0,1] op_sel_hi:[1,1]
    v_pk_mul_f32 v[90:91], v[82:83], v[48:49] op_sel:[0,1] op_sel_hi:[1,1]
    s_branch L_fr9
L_fl10:
    v_readlane_b32 s48, v106, 17
    s_nop 0
    v_permlane32_swap_b32 v84, v88
    s_bfe_u32 s48, s48, 0x60019
    s_mul_i32 s48, s48, 2112
    v_permlane32_swap_b32 v85, v89
    v_permlane32_swap_b32 v86, v90
    v_permlane32_swap_b32 v87, v91
    v_add_u32 v108, s48, v18
    v_pk_add_f32 v[84:85], v[84:85], v[88:89]
    v_cvt_f64_f32 v[88:89], v84
    v_cvt_f64_f32 v[84:85], v85
    ds_add_f64 v108, v[88:89] offset:0
    ds_add_f64 v108, v[84:85] offset:528
    v_pk_add_f32 v[86:87], v[86:87], v[90:91]
    v_cvt_f64_f32 v[90:91], v86
    v_cvt_f64_f32 v[86:87], v87
    ds_add_f64 v108, v[90:91] offset:1056
    ds_add_f64 v108, v[86:87] offset:1584
    v_pk_mul_f32 v[84:85], v[76:77], v[34:35] op_sel:[0,0] op_sel_hi:[1,0]
    v_pk_mul_f32 v[86:87], v[78:79], v[34:35] op_sel:[0,0] op_sel_hi:[1,0]
    v_pk_mul_f32 v[88:89], v[80:81], v[50:51] op_sel:[0,0] op_sel_hi:[1,0]
    v_pk_mul_f32 v[90:91], v[82:83], v[50:51] op_sel:[0,0] op_sel_hi:[1,0]
    s_branch L_fr10
L_fl11:
    v_readlane_b32 s48, v106, 18
    s_nop 0
    v_permlane32_swap_b32 v84, v88
    s_bfe_u32 s48, s48, 0x60019
    s_mul_i32 s48, s48, 2112
    v_permlane32_swap_b32 v85, v89
    v_permlane32_swap_b32 v86, v90
    v_permlane32_swap_b32 v87, v91
    v_add_u32 v108, s48, v18
    v_pk_add_f32 v[84:85], v[84:85], v[88:89]
    v_cvt_f64_f32 v[88:89], v84
    v_cvt_f64_f32 v[84:85], v85
    ds_add_f64 v108, v[88:89] offset:0
    ds_add_f64 v108, v[84:85] offset:528
    v_pk_add_f32 v[86:87], v[86:87], v[90:91]
    v_cvt_f64_f32 v[90:91], v86
    v_cvt_f64_f32 v[86:87], v87
    ds_add_f64 v108, v[90:91] offset:1056
    ds_add_f64 v108, v[86:87] offset:1584
    v_pk_mul_f32 v[84:85], v[76:77], v[34:35] op_sel:[0,1] op_sel_hi:[1,1]
    v_pk_mul_f32 v[86:87], v[78:79], v[34:35] op_sel:[0,1] op_sel_hi:[1,1]
    v_pk_mul_f32 v[88:89], v[80:81], v[50:51] op_sel:[0,1] op_sel_hi:[1,1]
    v_pk_mul_f32 v[90:91], v[82:83], v[50:51] op_sel:[0,1] op_sel_hi:[1,1]
    s_branch L_fr11
L_fl12:
    v_readlane_b32 s48, v106, 19
    s_nop 0
    v_permlane32_swap_b32 v84, v88
    s_bfe_u32 s48, s48, 0x60019
    s_mul_i32 s48, s48, 2112
    v_permlane32_swap_b32 v85, v89
    v_permlane32_swap_b32 v86, v90
    v_permlane32_swap_b32 v87, v91
    v_add_u32 v108, s48, v18
    v_pk_add_f32 v[84:85], v[84:85], v[88:89]
    v_cvt_f64_f32 v[88:89], v84
    v_cvt_f64_f32 v[84:85], v85
    ds_add_f64 v108, v[88:89] offset:0
    ds_add_f64 v108, v[84:85] offset:528
    v_pk_add_f32 v[86:87], v[86:87], v[90:91]
    v_cvt_f64_f32 v[90:91], v86
    v_cvt_f64_f32 v[86:87], v87
    ds_add_f64 v108, v[90:91] offset:1056
    ds_add_f64 v108, v[86:87] offset:1584
    v_pk_mul_f32 v[84:85], v[76:77], v[36:37] op_sel:[0,0] op_sel_hi:[1,0]
    v_pk_mul_f32 v[86:87], v[78:79], v[36:37] op_sel:[0,0] op_sel_hi:[1,0]
    v_pk_mul_f32 v[88:89], v[80:81], v[52:53] op_sel:[0,0] op_sel_hi:[1,0]
    v_pk_mul_f32 v[90:91], v[82:83], v[52:53] op_sel:[0,0] op_sel_hi:[1,0]
    s_branch L_fr12
L_fl13:
    v_readlane_b32 s48, v106, 24
    s_nop 0
    v_permlane32_swap_b32 v84, v88
    s_bfe_u32 s48, s48, 0x60019
    s_mul_i32 s48, s48, 2112
    v_permlane32_swap_b32 v85, v89
    v_permlane32_swap_b32 v86, v90
    v_permlane32_swap_b32 v87, v91
    v_add_u32 v108, s48, v18
    v_pk_add_f32 v[84:85], v[84:85], v[88:89]
    v_cvt_f64_f32 v[88:89], v84
    v_cvt_f64_f32 v[84:85], v85
    ds_add_f64 v108, v[88:89] offset:0
    ds_add_f64 v108, v[84:85] offset:528
    v_pk_add_f32 v[86:87], v[86:87], v[90:91]
    v_cvt_f64_f32 v[90:91], v86
    v_cvt_f64_f32 v[86:87], v87
    ds_add_f64 v108, v[90:91] offset:1056
    ds_add_f64 v108, v[86:87] offset:1584
    v_pk_mul_f32 v[84:85], v[76:77], v[36:37] op_sel:[0,1] op_sel_hi:[1,1]
    v_pk_mul_f32 v[86:87], v[78:79], v[36:37] op_sel:[0,1] op_sel_hi:[1,1]
    v_pk_mul_f32 v[88:89], v[80:81], v[52:53] op_sel:[0,1] op_sel_hi:[1,1]
    v_pk_mul_f32 v[90:91], v[82:83], v[52:53] op_sel:[0,1] op_sel_hi:[1,1]
    s_branch L_fr13
L_fl14:
    v_readlane_b32 s48, v106, 25
    s_nop 0
    v_permlane32_swap_b32 v84, v88
    s_bfe_u32 s48, s48, 0x60019
    s_mul_i32 s48, s48, 2112
    v_permlane32_swap_b32 v85, v89
    v_permlane32_swap_b32 v86, v90
    v_permlane32_swap_b32 v87, v91
    v_add_u32 v108, s48, v18
    v_pk_add_f32 v[84:85], v[84:85], v[88:89]
    v_cvt_f64_f32 v[88:89], v84
    v_cvt_f64_f32 v[84:85], v85
    ds_add_f64 v108, v[88:89] offset:0
    ds_add_f64 v108, v[84:85] offset:528
    v_pk_add_f32 v[86:87], v[86:87], v[90:91]
    v_cvt_f64_f32 v[90:91], v86
    v_cvt_f64_f32 v[86:87], v87
    ds_add_f64 v108, v[90:91] offset:1056
    ds_add_f64 v108, v[86:87] offset:1584
    v_pk_mul_f32 v[84:85], v[76:77], v[38:39] op_sel:[0,0] op_sel_hi:[1,0]
    v_pk_mul_f32 v[86:87], v[78:79], v[38:39] op_sel:[0,0] op_sel_hi:[1,0]
    v_pk_mul_f32 v[88:89], v[80:81], v[54:55] op_sel:[0,0] op_sel_hi:[1,0]
    v_pk_mul_f32 v[90:91], v[82:83], v[54:55] op_sel:[0,0] op_sel_hi:[1,0]
    s_branch L_fr14
L_fl15:
    v_readlane_b32 s48, v106, 26
    s_nop 0
    v_permlane32_swap_b32 v84, v88
    s_bfe_u32 s48, s48, 0x60019
    s_mul_i32 s48, s48, 2112
    v_permlane32_swap_b32 v85, v89
    v_permlane32_swap_b32 v86, v90
    v_permlane32_swap_b32 v87, v91
    v_add_u32 v108, s48, v18
    v_pk_add_f32 v[84:85], v[84:85], v[88:89]
    v_cvt_f64_f32 v[88:89], v84
    v_cvt_f64_f32 v[84:85], v85
    ds_add_f64 v108, v[88:89] offset:0
    ds_add_f64 v108, v[84:85] offset:528
    v_pk_add_f32 v[86:87], v[86:87], v[90:91]
    v_cvt_f64_f32 v[90:91], v86
    v_cvt_f64_f32 v[86:87], v87
    ds_add_f64 v108, v[90:91] offset:1056
    ds_add_f64 v108, v[86:87] offset:1584
    v_pk_mul_f32 v[84:85], v[76:77], v[38:39] op_sel:[0,1] op_sel_hi:[1,1]
    v_pk_mul_f32 v[86:87], v[78:79], v[38:39] op_sel:[0,1] op_sel_hi:[1,1]
    v_pk_mul_f32 v[88:89], v[80:81], v[54:55] op_sel:[0,1] op_sel_hi:[1,1]
    v_pk_mul_f32 v[90:91], v[82:83], v[54:55] op_sel:[0,1] op_sel_hi:[1,1]
    s_branch L_fr15
L_flt6:
    v_readlane_b32 s48, v106, 9
    s_nop 0
    v_permlane32_swap_b32 v84, v88
    s_bfe_u32 s48, s48, 0x60019
    s_mul_i32 s48, s48, 2112
    v_permlane32_swap_b32 v85, v89
    v_permlane32_swap_b32 v86, v90
    v_permlane32_swap_b32 v87, v91
    v_add_u32 v108, s48, v18
    v_pk_add_f32 v[84:85], v[84:85], v[88:89]
    v_cvt_f64_f32 v[88:89], v84
    v_cvt_f64_f32 v[84:85], v85
    ds_add_f64 v108, v[88:89] offset:0
    ds_add_f64 v108, v[84:85] offset:528
    v_pk_add_f32 v[86:87], v[86:87], v[90:91]
    v_cvt_f64_f32 v[90:91], v86
    v_cvt_f64_f32 v[86:87], v87
    ds_add_f64 v108, v[90:91] offset:1056
    ds_add_f64 v108, v[86:87] offset:1584
    v_pk_mul_f32 v[84:85], v[76:77], v[30:31] op_sel:[0,0] op_sel_hi:[1,0]
    v_pk_mul_f32 v[86:87], v[78:79], v[30:31] op_sel:[0,0] op_sel_hi:[1,0]
    v_pk_mul_f32 v[88:89], v[80:81], v[46:47] op_sel:[0,0] op_sel_hi:[1,0]
    v_pk_mul_f32 v[90:91], v[82:83], v[46:47] op_sel:[0,0] op_sel_hi:[1,0]
    s_branch L_frt6
L_flt7:
    v_readlane_b32 s48, v106, 10
    s_nop 0
    v_permlane32_swap_b32 v84, v88
    s_bfe_u32 s48, s48, 0x60019
    s_mul_i32 s48, s48, 2112
    v_permlane32_swap_b32 v85, v89
    v_permlane32_swap_b32 v86, v90
    v_permlane32_swap_b32 v87, v91
    v_add_u32 v108, s48, v18
    v_pk_add_f32 v[84:85], v[84:85], v[88:89]
    v_cvt_f64_f32 v[88:89], v84
    v_cvt_f64_f32 v[84:85], v85
    ds_add_f64 v108, v[88:89] offset:0
    ds_add_f64 v108, v[84:85] offset:528
    v_pk_add_f32 v[86:87], v[86:87], v[90:91]
    v_cvt_f64_f32 v[90:91], v86
    v_cvt_f64_f32 v[86:87], v87
    ds_add_f64 v108, v[90:91] offset:1056
    ds_add_f64 v108, v[86:87] offset:1584
    v_pk_mul_f32 v[84:85], v[76:77], v[30:31] op_sel:[0,1] op_sel_hi:[1,1]
    v_pk_mul_f32 v[86:87], v[78:79], v[30:31] op_sel:[0,1] op_sel_hi:[1,1]
    v_pk_mul_f32 v[88:89], v[80:81], v[46:47] op_sel:[0,1] op_sel_hi:[1,1]
    v_pk_mul_f32 v[90:91], v[82:83], v[46:47] op_sel:[0,1] op_sel_hi:[1,1]
    s_branch L_frt7
L_flt8:
    v_readlane_b32 s48, v106, 11
    s_nop 0
    v_permlane32_swap_b32 v84, v88
    s_bfe_u32 s48, s48, 0x60019
    s_mul_i32 s48, s48, 2112
    v_permlane32_swap_b32 v85, v89
    v_permlane32_swap_b32 v86, v90
    v_permlane32_swap_b32 v87, v91
    v_add_u32 v108, s48, v18
    v_pk_add_f32 v[84:85], v[84:85], v[88:89]
    v_cvt_f64_f32 v[88:89], v84
    v_cvt_f64_f32 v[84:85], v85
    ds_add_f64 v108, v[88:89] offset:0
    ds_add_f64 v108, v[84:85] offset:528
    v_pk_add_f32 v[86:87], v[86:87], v[90:91]
    v_cvt_f64_f32 v[90:91], v86
    v_cvt_f64_f32 v[86:87], v87
    ds_add_f64 v108, v[90:91] offset:1056
    ds_add_f64 v108, v[86:87] offset:1584
    v_pk_mul_f32 v[84:85], v[76:77], v[32:33] op_sel:[0,0] op_sel_hi:[1,0]
    v_pk_mul_f32 v[86:87], v[78:79], v[32:33] op_sel:[0,0] op_sel_hi:[1,0]
    v_pk_mul_f32 v[88:89], v[80:81], v[48:49] op_sel:[0,0] op_sel_hi:[1,0]
    v_pk_mul_f32 v[90:91], v[82:83], v[48:49] op_sel:[0,0] op_sel_hi:[1,0]
    s_branch L_frt8
L_flt9:
    v_readlane_b32 s48, v106, 16
    s_nop 0
    v_permlane32_swap_b32 v84, v88
    s_bfe_u32 s48, s48, 0x60019
    s_mul_i32 s48, s48, 2112
    v_permlane32_swap_b32 v85, v89
    v_permlane32_swap_b32 v86, v90
    v_permlane32_swap_b32 v87, v91
    v_add_u32 v108, s48, v18
    v_pk_add_f32 v[84:85], v[84:85], v[88:89]
    v_cvt_f64_f32 v[88:89], v84
    v_cvt_f64_f32 v[84:85], v85
    ds_add_f64 v108, v[88:89] offset:0
    ds_add_f64 v108, v[84:85] offset:528
    v_pk_add_f32 v[86:87], v[86:87], v[90:91]
    v_cvt_f64_f32 v[90:91], v86
    v_cvt_f64_f32 v[86:87], v87
    ds_add_f64 v108, v[90:91] offset:1056
    ds_add_f64 v108, v[86:87] offset:1584
    v_pk_mul_f32 v[84:85], v[76:77], v[32:33] op_sel:[0,1] op_sel_hi:[1,1]
    v_pk_mul_f32 v[86:87], v[78:79], v[32:33] op_sel:[0,1] op_sel_hi:[1,1]
    v_pk_mul_f32 v[88:89], v[80:81], v[48:49] op_sel:[0,1] op_sel_hi:[1,1]
    v_pk_mul_f32 v[90:91], v[82:83], v[48:49] op_sel:[0,1] op_sel_hi:[1,1]
    s_branch L_frt9
L_flt10:
    v_readlane_b32 s48, v106, 17
    s_nop 0
    v_permlane32_swap_b32 v84, v88
    s_bfe_u32 s48, s48, 0x60019
    s_mul_i32 s48, s48, 2112
    v_permlane32_swap_b32 v85, v89
    v_permlane32_swap_b32 v86, v90
    v_permlane32_swap_b32 v87, v91
    v_add_u32 v108, s48, v18
    v_pk_add_f32 v[84:85], v[84:85], v[88:89]
    v_cvt_f64_f32 v[88:89], v84
    v_cvt_f64_f32 v[84:85], v85
    ds_add_f64 v108, v[88:89] offset:0
    ds_add_f64 v108, v[84:85] offset:528
    v_pk_add_f32 v[86:87], v[86:87], v[90:91]
    v_cvt_f64_f32 v[90:91], v86
    v_cvt_f64_f32 v[86:87], v87
    ds_add_f64 v108, v[90:91] offset:1056
    ds_add_f64 v108, v[86:87] offset:1584
    v_pk_mul_f32 v[84:85], v[76:77], v[34:35] op_sel:[0,0] op_sel_hi:[1,0]
    v_pk_mul_f32 v[86:87], v[78:79], v[34:35] op_sel:[0,0] op_sel_hi:[1,0]
    v_pk_mul_f32 v[88:89], v[80:81], v[50:51] op_sel:[0,0] op_sel_hi:[1,0]
    v_pk_mul_f32 v[90:91], v[82:83], v[50:51] op_sel:[0,0] op_sel_hi:[1,0]
    s_branch L_frt10
L_flt11:
    v_readlane_b32 s48, v106, 18
    s_nop 0
    v_permlane32_swap_b32 v84, v88
    s_bfe_u32 s48, s48, 0x60019
    s_mul_i32 s48, s48, 2112
    v_permlane32_swap_b32 v85, v89
    v_permlane32_swap_b32 v86, v90
    v_permlane32_swap_b32 v87, v91
    v_add_u32 v108, s48, v18
    v_pk_add_f32 v[84:85], v[84:85], v[88:89]
    v_cvt_f64_f32 v[88:89], v84
    v_cvt_f64_f32 v[84:85], v85
    ds_add_f64 v108, v[88:89] offset:0
    ds_add_f64 v108, v[84:85] offset:528
    v_pk_add_f32 v[86:87], v[86:87], v[90:91]
    v_cvt_f64_f32 v[90:91], v86
    v_cvt_f64_f32 v[86:87], v87
    ds_add_f64 v108, v[90:91] offset:1056
    ds_add_f64 v108, v[86:87] offset:1584
    v_pk_mul_f32 v[84:85], v[76:77], v[34:35] op_sel:[0,1] op_sel_hi:[1,1]
    v_pk_mul_f32 v[86:87], v[78:79], v[34:35] op_sel:[0,1] op_sel_hi:[1,1]
    v_pk_mul_f32 v[88:89], v[80:81], v[50:51] op_sel:[0,1] op_sel_hi:[1,1]
    v_pk_mul_f32 v[90:91], v[82:83], v[50:51] op_sel:[0,1] op_sel_hi:[1,1]
    s_branch L_frt11
L_flt12:
    v_readlane_b32 s48, v106, 19
    s_nop 0
    v_permlane32_swap_b32 v84, v88
    s_bfe_u32 s48, s48, 0x60019
    s_mul_i32 s48, s48, 2112
    v_permlane32_swap_b32 v85, v89
    v_permlane32_swap_b32 v86, v90
    v_permlane32_swap_b32 v87, v91
    v_add_u32 v108, s48, v18
    v_pk_add_f32 v[84:85], v[84:85], v[88:89]
    v_cvt_f64_f32 v[88:89], v84
    v_cvt_f64_f32 v[84:85], v85
    ds_add_f64 v108, v[88:89] offset:0
    ds_add_f64 v108, v[84:85] offset:528
    v_pk_add_f32 v[86:87], v[86:87], v[90:91]
    v_cvt_f64_f32 v[90:91], v86
    v_cvt_f64_f32 v[86:87], v87
    ds_add_f64 v108, v[90:91] offset:1056
    ds_add_f64 v108, v[86:87] offset:1584
    v_pk_mul_f32 v[84:85], v[76:77], v[36:37] op_sel:[0,0] op_sel_hi:[1,0]
    v_pk_mul_f32 v[86:87], v[78:79], v[36:37] op_sel:[0,0] op_sel_hi:[1,0]
    v_pk_mul_f32 v[88:89], v[80:81], v[52:53] op_sel:[0,0] op_sel_hi:[1,0]
    v_pk_mul_f32 v[90:91], v[82:83], v[52:53] op_sel:[0,0] op_sel_hi:[1,0]
    s_branch L_frt12
L_flt13:
    v_readlane_b32 s48, v106, 24
    s_nop 0
    v_permlane32_swap_b32 v84, v88
    s_bfe_u32 s48, s48, 0x60019
    s_mul_i32 s48, s48, 2112
    v_permlane32_swap_b32 v85, v89
    v_permlane32_swap_b32 v86, v90
    v_permlane32_swap_b32 v87, v91
    v_add_u32 v108, s48, v18
    v_pk_add_f32 v[84:85], v[84:85], v[88:89]
    v_cvt_f64_f32 v[88:89], v84
    v_cvt_f64_f32 v[84:85], v85
    ds_add_f64 v108, v[88:89] offset:0
    ds_add_f64 v108, v[84:85] offset:528
    v_pk_add_f32 v[86:87], v[86:87], v[90:91]
    v_cvt_f64_f32 v[90:91], v86
    v_cvt_f64_f32 v[86:87], v87
    ds_add_f64 v108, v[90:91] offset:1056
    ds_add_f64 v108, v[86:87] offset:1584
    v_pk_mul_f32 v[84:85], v[76:77], v[36:37] op_sel:[0,1] op_sel_hi:[1,1]
    v_pk_mul_f32 v[86:87], v[78:79], v[36:37] op_sel:[0,1] op_sel_hi:[1,1]
    v_pk_mul_f32 v[88:89], v[80:81], v[52:53] op_sel:[0,1] op_sel_hi:[1,1]
    v_pk_mul_f32 v[90:91], v[82:83], v[52:53] op_sel:[0,1] op_sel_hi:[1,1]
    s_branch L_frt13
L_flt14:
    v_readlane_b32 s48, v106, 25
    s_nop 0
    v_permlane32_swap_b32 v84, v88
    s_bfe_u32 s48, s48, 0x60019
    s_mul_i32 s48, s48, 2112
    v_permlane32_swap_b32 v85, v89
    v_permlane32_swap_b32 v86, v90
    v_permlane32_swap_b32 v87, v91
    v_add_u32 v108, s48, v18
    v_pk_add_f32 v[84:85], v[84:85], v[88:89]
    v_cvt_f64_f32 v[88:89], v84
    v_cvt_f64_f32 v[84:85], v85
    ds_add_f64 v108, v[88:89] offset:0
    ds_add_f64 v108, v[84:85] offset:528
    v_pk_add_f32 v[86:87], v[86:87], v[90:91]
    v_cvt_f64_f32 v[90:91], v86
    v_cvt_f64_f32 v[86:87], v87
    ds_add_f64 v108, v[90:91] offset:1056
    ds_add_f64 v108, v[86:87] offset:1584
    v_pk_mul_f32 v[84:85], v[76:77], v[38:39] op_sel:[0,0] op_sel_hi:[1,0]
    v_pk_mul_f32 v[86:87], v[78:79], v[38:39] op_sel:[0,0] op_sel_hi:[1,0]
    v_pk_mul_f32 v[88:89], v[80:81], v[54:55] op_sel:[0,0] op_sel_hi:[1,0]
    v_pk_mul_f32 v[90:91], v[82:83], v[54:55] op_sel:[0,0] op_sel_hi:[1,0]
    s_branch L_frt14
L_flt15:
    v_readlane_b32 s48, v106, 26
    s_nop 0
    v_permlane32_swap_b32 v84, v88
    s_bfe_u32 s48, s48, 0x60019
    s_mul_i32 s48, s48, 2112
    v_permlane32_swap_b32 v85, v89
    v_permlane32_swap_b32 v86, v90
    v_permlane32_swap_b32 v87, v91
    v_add_u32 v108, s48, v18
    v_pk_add_f32 v[84:85], v[84:85], v[88:89]
    v_cvt_f64_f32 v[88:89], v84
    v_cvt_f64_f32 v[84:85], v85
    ds_add_f64 v108, v[88:89] offset:0
    ds_add_f64 v108, v[84:85] offset:528
    v_pk_add_f32 v[86:87], v[86:87], v[90:91]
    v_cvt_f64_f32 v[90:91], v86
    v_cvt_f64_f32 v[86:87], v87
    ds_add_f64 v108, v[90:91] offset:1056
    ds_add_f64 v108, v[86:87] offset:1584
    v_pk_mul_f32 v[84:85], v[76:77], v[38:39] op_sel:[0,1] op_sel_hi:[1,1]
    v_pk_mul_f32 v[86:87], v[78:79], v[38:39] op_sel:[0,1] op_sel_hi:[1,1]
    v_pk_mul_f32 v[88:89], v[80:81], v[54:55] op_sel:[0,1] op_sel_hi:[1,1]
    v_pk_mul_f32 v[90:91], v[82:83], v[54:55] op_sel:[0,1] op_sel_hi:[1,1]
    s_branch L_frt15
L_tail:
    s_setprio 1
    v_add_u32_dpp v74, v72, v1 row_newbcast:10 row_mask:0xf bank_mask:0xf
    buffer_load_dwordx4 v[64:67], v74, s[12:15], 0 offen
    s_bitcmp1_b32 s47, 10
    s_cbranch_scc1 L_flt6
    v_pk_fma_f32 v[84:85], v[76:77], v[30:31], v[84:85] op_sel:[0,0,0] op_sel_hi:[1,0,1]
    v_pk_fma_f32 v[86:87], v[78:79], v[30:31], v[86:87] op_sel:[0,0,0] op_sel_hi:[1,0,1]
    v_pk_fma_f32 v[88:89], v[80:81], v[46:47], v[88:89] op_sel:[0,0,0] op_sel_hi:[1,0,1]
    v_pk_fma_f32 v[90:91], v[82:83], v[46:47], v[90:91] op_sel:[0,0,0] op_sel_hi:[1,0,1]
L_frt6:
    v_pk_add_f32 v[100:101], v[100:101], 1.0 op_sel_hi:[1,0]
    v_pk_add_f32 v[102:103], v[102:103], 1.0 op_sel_hi:[1,0]
    s_waitcnt vmcnt(3)
    v_mfma_f32_4x4x4_16b_bf16 v[76:79], v[92:93], v[68:69], 0 cbsz:3 abid:7
    v_rcp_f32 v100, v100
    v_mfma_f32_4x4x4_16b_bf16 v[80:83], v[92:93], v[70:71], 0 cbsz:3 abid:7
    v_add_u32_dpp v75, v72, v1 row_newbcast:11 row_mask:0xf bank_mask:0xf
    buffer_load_dwordx4 v[68:71], v75, s[12:15], 0 offen
    v_rcp_f32 v101, v101
    v_rcp_f32 v102, v102
    v_rcp_f32 v103, v103
    s_bitcmp1_b32 s47, 11
    s_cbranch_scc1 L_flt7
    v_pk_fma_f32 v[84:85], v[76:77], v[30:31], v[84:85] op_sel:[0,1,0] op_sel_hi:[1,1,1]
    v_pk_fma_f32 v[86:87], v[78:79], v[30:31], v[86:87] op_sel:[0,1,0] op_sel_hi:[1,1,1]
    v_pk_fma_f32 v[88:89], v[80:81], v[46:47], v[88:89] op_sel:[0,1,0] op_sel_hi:[1,1,1]
    v_pk_fma_f32 v[90:91], v[82:83], v[46:47], v[90:91] op_sel:[0,1,0] op_sel_hi:[1,1,1]
L_frt7:
    v_pk_mul_f32 v[32:33], v[32:33], v[100:101]
    v_pk_mul_f32 v[48:49], v[48:49], v[102:103]
    s_waitcnt vmcnt(3)
    v_mfma_f32_4x4x4_16b_bf16 v[76:79], v[94:95], v[56:57], 0 cbsz:3 abid:0
    v_exp_f32 v100, v34
    v_mfma_f32_4x4x4_16b_bf16 v[80:83], v[94:95], v[58:59], 0 cbsz:3 abid:0
    v_add_u32_dpp v74, v72, v1 row_newbcast:12 row_mask:0xf bank_mask:0xf
    buffer_load_dwordx4 v[56:59], v74, s[12:15], 0 offen
    v_exp_f32 v101, v35
    v_exp_f32 v102, v50
    v_exp_f32 v103, v51
    s_bitcmp1_b32 s47, 16
    s_cbranch_scc1 L_flt8
    v_pk_fma_f32 v[84:85], v[76:77], v[32:33], v[84:85] op_sel:[0,0,0] op_sel_hi:[1,0,1]
    v_pk_fma_f32 v[86:87], v[78:79], v[32:33], v[86:87] op_sel:[0,0,0] op_sel_hi:[1,0,1]
    v_pk_fma_f32 v[88:89], v[80:81], v[48:49], v[88:89] op_sel:[0,0,0] op_sel_hi:[1,0,1]
    v_pk_fma_f32 v[90:91], v[82:83], v[48:49], v[90:91] op_sel:[0,0,0] op_sel_hi:[1,0,1]
L_frt8:
    v_pk_add_f32 v[100:101], v[100:101], 1.0 op_sel_hi:[1,0]
    v_pk_add_f32 v[102:103], v[102:103], 1.0 op_sel_hi:[1,0]
    s_waitcnt vmcnt(3)
    v_mfma_f32_4x4x4_16b_bf16 v[76:79], v[94:95], v[60:61], 0 cbsz:3 abid:1
    v_rcp_f32 v100, v100
    v_mfma_f32_4x4x4_16b_bf16 v[80:83], v[94:95], v[62:63], 0 cbsz:3 abid:1
    v_add_u32_dpp v75, v72, v1 row_newbcast:13 row_mask:0xf bank_mask:0xf
    buffer_load_dwordx4 v[60:63], v75, s[12:15], 0 offen
    v_rcp_f32 v101, v101
    v_rcp_f32 v102, v102
    v_rcp_f32 v103, v103
    s_bitcmp1_b32 s47, 17
    s_cbranch_scc1 L_flt9
    v_pk_fma_f32 v[84:85], v[76:77], v[32:33], v[84:85] op_sel:[0,1,0] op_sel_hi:[1,1,1]
    v_pk_fma_f32 v[86:87], v[78:79], v[32:33], v[86:87] op_sel:[0,1,0] op_sel_hi:[1,1,1]
    v_pk_fma_f32 v[88:89], v[80:81], v[48:49], v[88:89] op_sel:[0,1,0] op_sel_hi:[1,1,1]
    v_pk_fma_f32 v[90:91], v[82:83], v[48:49], v[90:91] op_sel:[0,1,0] op_sel_hi:[1,1,1]
L_frt9:
    v_pk_mul_f32 v[34:35], v[34:35], v[100:101]
    v_pk_mul_f32 v[50:51], v[50:51], v[102:103]
    s_waitcnt vmcnt(3)
    v_mfma_f32_4x4x4_16b_bf16 v[76:79], v[94:95], v[64:65], 0 cbsz:3 abid:2
    v_exp_f32 v100, v36
    v_mfma_f32_4x4x4_16b_bf16 v[80:83], v[94:95], v[66:67], 0 cbsz:3 abid:2
    v_add_u32_dpp v74, v72, v1 row_newbcast:14 row_mask:0xf bank_mask:0xf
    buffer_load_dwordx4 v[64:67], v74, s[12:15], 0 offen
    v_exp_f32 v101, v37
    v_exp_f32 v102, v52
    v_exp_f32 v103, v53
    s_bitcmp1_b32 s47, 18
    s_cbranch_scc1 L_flt10
    v_pk_fma_f32 v[84:85], v[76:77], v[34:35], v[84:85] op_sel:[0,0,0] op_sel_hi:[1,0,1]
    v_pk_fma_f32 v[86:87], v[78:79], v[34:35], v[86:87] op_sel:[0,0,0] op_sel_hi:[1,0,1]
    v_pk_fma_f32 v[88:89], v[80:81], v[50:51], v[88:89] op_sel:[0,0,0] op_sel_hi:[1,0,1]
    v_pk_fma_f32 v[90:91], v[82:83], v[50:51], v[90:91] op_sel:[0,0,0] op_sel_hi:[1,0,1]
L_frt10:
    v_pk_add_f32 v[100:101], v[100:101], 1.0 op_sel_hi:[1,0]
    v_pk_add_f32 v[102:103], v[102:103], 1.0 op_sel_hi:[1,0]
    s_setprio 0
    s_waitcnt vmcnt(3)
    v_mfma_f32_4x4x4_16b_bf16 v[76:79], v[94:95], v[68:69], 0 cbsz:3 abid:3
    v_rcp_f32 v100, v100
    v_mfma_f32_4x4x4_16b_bf16 v[80:83], v[94:95], v[70:71], 0 cbsz:3 abid:3
    v_add_u32_dpp v75, v72, v1 row_newbcast:15 row_mask:0xf bank_mask:0xf
    buffer_load_dwordx4 v[68:71], v75, s[12:15], 0 offen
    v_rcp_f32 v101, v101
    v_rcp_f32 v102, v102
    v_rcp_f32 v103, v103
    s_bitcmp1_b32 s47, 19
    s_cbranch_scc1 L_flt11
    v_pk_fma_f32 v[84:85], v[76:77], v[34:35], v[84:85] op_sel:[0,1,0] op_sel_hi:[1,1,1]
    v_pk_fma_f32 v[86:87], v[78:79], v[34:35], v[86:87] op_sel:[0,1,0] op_sel_hi:[1,1,1]
    v_pk_fma_f32 v[88:89], v[80:81], v[50:51], v[88:89] op_sel:[0,1,0] op_sel_hi:[1,1,1]
    v_pk_fma_f32 v[90:91], v[82:83], v[50:51], v[90:91] op_sel:[0,1,0] op_sel_hi:[1,1,1]
L_frt11:
    v_pk_mul_f32 v[36:37], v[36:37], v[100:101]
    v_pk_mul_f32 v[52:53], v[52:53], v[102:103]
    s_waitcnt vmcnt(3)
    v_mfma_f32_4x4x4_16b_bf16 v[76:79], v[94:95], v[56:57], 0 cbsz:3 abid:4
    v_exp_f32 v100, v38
    v_mfma_f32_4x4x4_16b_bf16 v[80:83], v[94:95], v[58:59], 0 cbsz:3 abid:4
    v_exp_f32 v101, v39
    v_exp_f32 v102, v54
    v_exp_f32 v103, v55
    s_bitcmp1_b32 s47, 24
    s_cbranch_scc1 L_flt12
    v_pk_fma_f32 v[84:85], v[76:77], v[36:37], v[84:85] op_sel:[0,0,0] op_sel_hi:[1,0,1]
    v_pk_fma_f32 v[86:87], v[78:79], v[36:37], v[86:87] op_sel:[0,0,0] op_sel_hi:[1,0,1]
    v_pk_fma_f32 v[88:89], v[80:81], v[52:53], v[88:89] op_sel:[0,0,0] op_sel_hi:[1,0,1]
    v_pk_fma_f32 v[90:91], v[82:83], v[52:53], v[90:91] op_sel:[0,0,0] op_sel_hi:[1,0,1]
L_frt12:
    v_pk_add_f32 v[100:101], v[100:101], 1.0 op_sel_hi:[1,0]
    v_pk_add_f32 v[102:103], v[102:103], 1.0 op_sel_hi:[1,0]
    s_waitcnt vmcnt(2)
    v_mfma_f32_4x4x4_16b_bf16 v[76:79], v[94:95], v[60:61], 0 cbsz:3 abid:5
    v_rcp_f32 v100, v100
    v_mfma_f32_4x4x4_16b_bf16 v[80:83], v[94:95], v[62:63], 0 cbsz:3 abid:5
    v_rcp_f32 v101, v101
    v_rcp_f32 v102, v102
    v_rcp_f32 v103, v103
    s_bitcmp1_b32 s47, 25
    s_cbranch_scc1 L_flt13
    v_pk_fma_f32 v[84:85], v[76:77], v[36:37], v[84:85] op_sel:[0,1,0] op_sel_hi:[1,1,1]
    v_pk_fma_f32 v[86:87], v[78:79], v[36:37], v[86:87] op_sel:[0,1,0] op_sel_hi:[1,1,1]
    v_pk_fma_f32 v[88:89], v[80:81], v[52:53], v[88:89] op_sel:[0,1,0] op_sel_hi:[1,1,1]
    v_pk_fma_f32 v[90:91], v[82:83], v[52:53], v[90:91] op_sel:[0,1,0] op_sel_hi:[1,1,1]
L_frt13:
    v_pk_mul_f32 v[38:39], v[38:39], v[100:101]
    v_pk_mul_f32 v[54:55], v[54:55], v[102:103]
    s_waitcnt vmcnt(1)
    v_mfma_f32_4x4x4_16b_bf16 v[76:79], v[94:95], v[64:65], 0 cbsz:3 abid:6
    v_mfma_f32_4x4x4_16b_bf16 v[80:83], v[94:95], v[66:67], 0 cbsz:3 abid:6
    s_nop 1
    s_bitcmp1_b32 s47, 26
    s_cbranch_scc1 L_flt14
    v_pk_fma_f32 v[84:85], v[76:77], v[38:39], v[84:85] op_sel:[0,0,0] op_sel_hi:[1,0,1]
    v_pk_fma_f32 v[86:87], v[78:79], v[38:39], v[86:87] op_sel:[0,0,0] op_sel_hi:[1,0,1]
    v_pk_fma_f32 v[88:89], v[80:81], v[54:55], v[88:89] op_sel:[0,0,0] op_sel_hi:[1,0,1]
    v_pk_fma_f32 v[90:91], v[82:83], v[54:55], v[90:91] op_sel:[0,0,0] op_sel_hi:[1,0,1]
L_frt14:
    s_waitcnt vmcnt(0)
    v_mfma_f32_4x4x4_16b_bf16 v[76:79], v[94:95], v[68:69], 0 cbsz:3 abid:7
    v_mfma_f32_4x4x4_16b_bf16 v[80:83], v[94:95], v[70:71], 0 cbsz:3 abid:7
    s_nop 1
    s_bitcmp1_b32 s47, 27
    s_cbranch_scc1 L_flt15
    v_pk_fma_f32 v[84:85], v[76:77], v[38:39], v[84:85] op_sel:[0,1,0] op_sel_hi:[1,1,1]
    v_pk_fma_f32 v[86:87], v[78:79], v[38:39], v[86:87] op_sel:[0,1,0] op_sel_hi:[1,1,1]
    v_pk_fma_f32 v[88:89], v[80:81], v[54:55], v[88:89] op_sel:[0,1,0] op_sel_hi:[1,1,1]
    v_pk_fma_f32 v[90:91], v[82:83], v[54:55], v[90:91] op_sel:[0,1,0] op_sel_hi:[1,1,1]
L_frt15:
    v_readlane_b32 s48, v106, 27
    s_nop 0
    v_permlane32_swap_b32 v84, v88
    s_bfe_u32 s48, s48, 0x60019
    s_mul_i32 s48, s48, 2112
    v_permlane32_swap_b32 v85, v89
    v_permlane32_swap_b32 v86, v90
    v_permlane32_swap_b32 v87, v91
    v_add_u32 v108, s48, v18
    v_pk_add_f32 v[84:85], v[84:85], v[88:89]
    v_cvt_f64_f32 v[88:89], v84
    v_cvt_f64_f32 v[84:85], v85
    ds_add_f64 v108, v[88:89] offset:0
    ds_add_f64 v108, v[84:85] offset:528
    v_pk_add_f32 v[86:87], v[86:87], v[90:91]
    v_cvt_f64_f32 v[90:91], v86
    v_cvt_f64_f32 v[86:87], v87
    ds_add_f64 v108, v[90:91] offset:1056
    ds_add_f64 v108, v[86:87] offset:1584
L_done:
    s_setprio 0
    s_waitcnt vmcnt(0) lgkmcnt(0)
    s_cmp_eq_u32 s41, s42
    s_cbranch_scc1 L_lastq
    s_add_u32 s41, s41, 1
    s_barrier
    s_branch L_round
L_lastq:
    s_cmp_eq_u32 s51, 0
    s_cbranch_scc1 L_epi
    s_add_u32 s40, s40, 1
    s_mov_b32 s41, 0
    s_mov_b32 s42, 0
    s_barrier
    s_branch L_round
L_epi:
    v_and_b32 v4, 63, v0
    v_lshrrev_b32 v2, 5, v4
    v_bfe_u32 v3, v4, 2, 2
    v_lshl_add_u32 v2, v2, 4, v3
    v_bfe_u32 v6, v4, 4, 1
    v_lshl_add_u32 v2, v2, 1, v6
    v_mul_u32_u24 v2, 144, v2
    v_and_b32 v3, 3, v4
    v_lshl_add_u32 v2, v3, 3, v2
    v_add_u32 v2, 136384, v2
    ds_read_b64_tr_b16 v[24:25], v2 offset:0
    ds_read_b64_tr_b16 v[26:27], v2 offset:1152
    ds_read_b64_tr_b16 v[28:29], v2 offset:2304
    ds_read_b64_tr_b16 v[30:31], v2 offset:3456
    ds_read_b64_tr_b16 v[32:33], v2 offset:64
    ds_read_b64_tr_b16 v[34:35], v2 offset:1216
    ds_read_b64_tr_b16 v[36:37], v2 offset:2368
    ds_read_b64_tr_b16 v[38:39], v2 offset:3520
    ds_read_b64_tr_b16 v[40:41], v2 offset:32
    ds_read_b64_tr_b16 v[42:43], v2 offset:1184
    ds_read_b64_tr_b16 v[44:45], v2 offset:2336
    ds_read_b64_tr_b16 v[46:47], v2 offset:3488
    ds_read_b64_tr_b16 v[48:49], v2 offset:96
    ds_read_b64_tr_b16 v[50:51], v2 offset:1248
    ds_read_b64_tr_b16 v[52:53], v2 offset:2400
    ds_read_b64_tr_b16 v[54:55], v2 offset:3552
    v_and_b32 v5, 15, v4
    v_mul_u32_u24 v2, 528, v5
    v_lshl_add_u32 v2, v6, 8, v2
    v_lshrrev_b32 v3, 5, v4
    v_lshl_add_u32 v2, v3, 7, v2
    s_mul_i32 s48, s39, 8448
    s_add_u32 s48, s48, 49664
    v_add_u32 v2, s48, v2
    s_lshl_b32 s48, s39, 2
    s_add_u32 s48, s48, s37
    v_lshrrev_b32 v3, 4, v4
    v_add_u32 v3, s48, v3
    v_cmp_gt_u32 vcc, s38, v3
    v_lshlrev_b32 v3, 9, v3
    v_lshl_add_u32 v3, v5, 4, v3
    s_mov_b32 s48, 0xbf317218
    s_mov_b32 s49, 0xbf317218
    s_barrier
    s_cmp_ge_u32 s39, 10
    s_cbranch_scc1 L_end
    ds_read_b128 v[56:59], v2 offset:0
    ds_read_b128 v[60:63], v2 offset:16
    ds_read_b128 v[64:67], v2 offset:32
    ds_read_b128 v[68:71], v2 offset:48
    ds_read_b128 v[72:75], v2 offset:64
    ds_read_b128 v[76:79], v2 offset:80
    ds_read_b128 v[80:83], v2 offset:96
    ds_read_b128 v[84:87], v2 offset:112
    s_waitcnt lgkmcnt(7)
    v_cvt_f32_f64 v56, v[56:57]
    v_cvt_f32_f64 v57, v[58:59]
    v_pk_mul_f32 v[56:57], v[56:57], s[48:49]
    v_cvt_pk_bf16_f32 v88, v56, v57
    s_waitcnt lgkmcnt(6)
    v_cvt_f32_f64 v60, v[60:61]
    v_cvt_f32_f64 v61, v[62:63]
    v_pk_mul_f32 v[60:61], v[60:61], s[48:49]
    v_cvt_pk_bf16_f32 v89, v60, v61
    s_waitcnt lgkmcnt(5)
    v_cvt_f32_f64 v64, v[64:65]
    v_cvt_f32_f64 v65, v[66:67]
    v_pk_mul_f32 v[64:65], v[64:65], s[48:49]
    v_cvt_pk_bf16_f32 v90, v64, v65
    s_waitcnt lgkmcnt(4)
    v_cvt_f32_f64 v68, v[68:69]
    v_cvt_f32_f64 v69, v[70:71]
    v_pk_mul_f32 v[68:69], v[68:69], s[48:49]
    v_cvt_pk_bf16_f32 v91, v68, v69
    s_waitcnt lgkmcnt(3)
    v_cvt_f32_f64 v72, v[72:73]
    v_cvt_f32_f64 v73, v[74:75]
    v_pk_mul_f32 v[72:73], v[72:73], s[48:49]
    v_cvt_pk_bf16_f32 v92, v72, v73
    s_waitcnt lgkmcnt(2)
    v_cvt_f32_f64 v76, v[76:77]
    v_cvt_f32_f64 v77, v[78:79]
    v_pk_mul_f32 v[76:77], v[76:77], s[48:49]
    v_cvt_pk_bf16_f32 v93, v76, v77
    s_waitcnt lgkmcnt(1)
    v_cvt_f32_f64 v80, v[80:81]
    v_cvt_f32_f64 v81, v[82:83]
    v_pk_mul_f32 v[80:81], v[80:81], s[48:49]
    v_cvt_pk_bf16_f32 v94, v80, v81
    s_waitcnt lgkmcnt(0)
    v_cvt_f32_f64 v84, v[84:85]
    v_cvt_f32_f64 v85, v[86:87]
    v_pk_mul_f32 v[84:85], v[84:85], s[48:49]
    v_cvt_pk_bf16_f32 v95, v84, v85
    s_nop 1
    v_mfma_f32_16x16x32_bf16 v[96:99], v[88:91], v[24:27], 0
    v_mfma_f32_16x16x32_bf16 v[100:103], v[88:91], v[32:35], 0
    v_mfma_f32_16x16x32_bf16 v[104:107], v[88:91], v[40:43], 0
    v_mfma_f32_16x16x32_bf16 v[108:111], v[88:91], v[48:51], 0
    v_mfma_f32_16x16x32_bf16 v[96:99], v[92:95], v[28:31], v[96:99]
    v_mfma_f32_16x16x32_bf16 v[100:103], v[92:95], v[36:39], v[100:103]
    v_mfma_f32_16x16x32_bf16 v[104:107], v[92:95], v[44:47], v[104:107]
    v_mfma_f32_16x16x32_bf16 v[108:111], v[92:95], v[52:55], v[108:111]
    s_nop 4
    v_cvt_pk_bf16_f32 v56, v96, v97
    v_cvt_pk_bf16_f32 v57, v98, v99
    v_cvt_pk_bf16_f32 v58, v100, v101
    v_cvt_pk_bf16_f32 v59, v102, v103
    v_cvt_pk_bf16_f32 v60, v104, v105
    v_cvt_pk_bf16_f32 v61, v106, v107
    v_cvt_pk_bf16_f32 v62, v108, v109
    v_cvt_pk_bf16_f32 v63, v110, v111
    s_and_b64 exec, exec, vcc
    s_cbranch_execz L_end
    buffer_store_dwordx4 v[56:59], v3, s[32:35], 0 offen sc1
    buffer_store_dwordx4 v[60:63], v3, s[32:35], 0 offen offset:256 sc1
L_end:
    s_endpgm
.section .rodata,"a"
.p2align 6
.amdhsa_kernel standalone__tensor_product_equiv_tfn__graph_kernel
  .amdhsa_next_free_vgpr 116
  .amdhsa_next_free_sgpr 76
  .amdhsa_accum_offset 116
  .amdhsa_group_segment_fixed_size 0
  .amdhsa_kernarg_size 88
  .amdhsa_user_sgpr_count 2
  .amdhsa_user_sgpr_kernarg_segment_ptr 1
  .amdhsa_system_sgpr_workgroup_id_x 1
  .amdhsa_float_denorm_mode_32 3
.end_amdhsa_kernel
```
